```python
import torch

def _softmax(x, axis=-1):
    return torch.softmax(x, dim=axis)

def _gelu(x):
    return torch.nn.functional.gelu(x, approximate='tanh')

def _silu(x):
    return torch.nn.functional.silu(x)

def _sigmoid(x):
    return torch.sigmoid(x)

def _layernorm(x, axis=-1, eps=1e-05):
    m = x.mean(dim=axis, keepdim=True)
    v = x.var(dim=axis, keepdim=True, unbiased=False)
    return (x - m) / torch.sqrt(v + eps)

def _scatter_add(tgt, idx, src, axis=0):
    return tgt.clone().index_add_(axis, idx, src)

def _segment_sum(src, seg, n):
    out = torch.zeros((n,) + src.shape[1:], dtype=src.dtype)
    return out.index_add_(0, seg, src)

def _pad(x, pw):
    flat = tuple((v for pair in reversed(pw) for v in pair))
    return torch.nn.functional.pad(x, flat)
kernel_name = 'adaLN_cond__sliding_block_cached__glu_gated_reglu__decode'

def setup_inputs():

    _w = lambda a: (lambda t: t.to(torch.bfloat16) if t.is_floating_point() else t)(torch.as_tensor(a))

    def _A_setup():
        B, Sq, D = (4, 1, 640)
        Hq, Hkv, Sk, Dh = (32, 32, 4096, 192)
        assert Hq % Hkv == 0, (Hq, Hkv)
        return {'x': _w((lambda *s: torch.randn(*s, dtype=torch.bfloat16) * 0.1)(B, Sq, D)), 'k_cache': _w((lambda *s: torch.randn(*s, dtype=torch.bfloat16) * 0.8)(B, Hkv, Sk, Dh)), 'v_cache': _w((lambda *s: torch.randn(*s, dtype=torch.bfloat16) * 3.2)(B, Hkv, Sk, Dh)), 'wq': _w((lambda *s: torch.randn(*s, dtype=torch.bfloat16) * 0.8)(D, Hq * Dh) * D ** (-0.5)), 'wo': _w((lambda *s: torch.randn(*s, dtype=torch.bfloat16) * 3.2)(Hq * Dh, D) * (Hq * Dh) ** (-0.5))}
    _A_in = _A_setup()

    def _B_setup():
        B, S, D, F = (4, 1, 640, 1536)
        return {'x': _w((lambda *s: torch.randn(*s, dtype=torch.bfloat16) * 0.1)(B, S, D)), 'W_gate': _w((lambda *s: torch.randn(*s, dtype=torch.bfloat16) * 3.2)(D, F) * (2.0 / D) ** 0.5), 'W_up': _w((lambda *s: torch.randn(*s, dtype=torch.bfloat16) * 3.2)(D, F) * (2.0 / D) ** 0.5), 'W_down': _w((lambda *s: torch.randn(*s, dtype=torch.bfloat16) * 3.2)(F, D) * (1.0 / F) ** 0.5)}
    _B_in = _B_setup()
    return {'A_x': _A_in['x'], 'A_k_cache': _A_in['k_cache'], 'A_v_cache': _A_in['v_cache'], 'A_wq': _A_in['wq'], 'A_wo': _A_in['wo'], 'B_x': _B_in['x'], 'B_W_gate': _B_in['W_gate'], 'B_W_up': _B_in['W_up'], 'B_W_down': _B_in['W_down'], 'c': _w((lambda *s: torch.randn(*s, dtype=torch.bfloat16) * 0.4)(4, 640) * 8.0), 'w_mod': _w((lambda *s: torch.randn(*s, dtype=torch.bfloat16) * 0.4)(640, 6 * 640) * 640 ** (-0.5) * 8.0)}

def reference(A_x, A_k_cache, A_v_cache, A_wq, A_wo, B_x, B_W_gate, B_W_up, B_W_down, c, w_mod):

    def _A_ref(x, k_cache, v_cache, wq, wo):
        B, Sq, D = x.shape
        Hq, Dh = (32, 192)
        Hkv, Sk = (k_cache.shape[1], k_cache.shape[2])
        W = min(4096, max(256, Sk // 4))
        rep = Hq // Hkv
        q = (lambda x, *d: x.permute(*d))((x @ wq).reshape(B, Sq, Hq, Dh), 0, 2, 1, 3)
        k = (lambda x, n, axis: torch.repeat_interleave(x, n, dim=axis))(k_cache[:, :, Sk - W:, :], rep, axis=1)
        v = (lambda x, n, axis: torch.repeat_interleave(x, n, dim=axis))(v_cache[:, :, Sk - W:, :], rep, axis=1)
        scores = torch.einsum('bhqd,bhkd->bhqk', q, k) * Dh ** (-0.5)
        p = _softmax(scores, axis=-1)
        o = torch.einsum('bhqk,bhkd->bhqd', p, v)
        return (lambda x, *d: x.permute(*d))(o, 0, 2, 1, 3).reshape(B, Sq, Hq * Dh) @ wo

    def _B_ref(x, W_gate, W_up, W_down):
        gate = torch.einsum('bsd,df->bsf', x, W_gate)
        up = torch.einsum('bsd,df->bsf', x, W_up)
        gate = gate * (lambda x, dt: x.to(dt))(gate > 0, gate.dtype)
        h = gate * up
        return torch.einsum('bsf,fd->bsd', h, W_down)
    x = A_x
    mod = (_silu(c) @ w_mod).reshape(c.shape[0], 6, 1, -1)
    sa, ca, ga, sb, cb, gb = (mod[:, 0].clone(), mod[:, 1].clone(), mod[:, 2].clone(), mod[:, 3].clone(), mod[:, 4].clone(), mod[:, 5].clone())
    h = _layernorm(x, axis=-1) * (1 + ca) + sa
    x = x + ga * _A_ref(h, A_k_cache, A_v_cache, A_wq, A_wo)
    h = _layernorm(x, axis=-1) * (1 + cb) + sb
    x = x + gb * _B_ref(h, B_W_gate, B_W_up, B_W_down)
    return x
```

```asm
; @launch grid=(256,1,1) block=(768,1,1) lds=162816
.amdgcn_target "amdgcn-amd-amdhsa--gfx950"
.text
.globl adaLN_cond__sliding_block_cached__glu_gated_reglu__decode_kernel
.p2align 8
.type adaLN_cond__sliding_block_cached__glu_gated_reglu__decode_kernel,@function
adaLN_cond__sliding_block_cached__glu_gated_reglu__decode_kernel:
    s_cmp_ge_u32 s2, 256
    s_cbranch_scc1 L_end
    s_load_dwordx16 s[16:31], s[0:1], 0
    s_load_dwordx8 s[32:39], s[0:1], 64
    s_load_dwordx4 s[40:43], s[0:1], 96
    v_lshrrev_b32 v2, 6, v0
    v_and_b32 v1, 63, v0
    s_mov_b32 s68, s2
    s_and_b32 s69, s2, 7
    s_lshl_b32 s69, s69, 2
    s_bfe_u32 s4, s2, 0x20003
    s_add_u32 s69, s69, s4
    s_sub_u32 s4, s2, 4
    s_add_u32 s5, s2, 80
    s_cmp_lt_u32 s2, 160
    s_cselect_b32 s4, s5, s4
    s_cmp_lt_u32 s2, 156
    s_cselect_b32 s4, s2, s4
    s_cmp_ge_u32 s2, 240
    s_cselect_b32 s2, s2, s4
    v_readfirstlane_b32 s3, v2
    s_nop 0
    s_cmp_lt_u32 s3, 8
    s_nop 1
    s_cbranch_scc1 L_A
    s_getpc_b64 s[4:5]
L_pc0:
    s_sub_u32 s4, s4, L_pc0-adaLN_cond__sliding_block_cached__glu_gated_reglu__decode_kernel
    s_subb_u32 s5, s5, 0
    s_lshr_b32 s6, s68, 3
    s_lshl_b32 s6, s6, 2
    s_add_u32 s6, s6, s3
    s_add_u32 s7, s6, 0
    s_and_b32 s7, s7, 31
    s_cmp_ge_u32 s7, (L_code_end-adaLN_cond__sliding_block_cached__glu_gated_reglu__decode_kernel)/1024
    s_cbranch_scc1 L_pfe_1
    s_lshl_b32 s7, s7, 10
    v_lshl_add_u32 v8, v1, 4, s7
    global_load_dwordx4 v[160:163], v8, s[4:5]
L_pfe_1:
    s_add_u32 s7, s6, 11
    s_and_b32 s7, s7, 31
    s_cmp_ge_u32 s7, (L_code_end-adaLN_cond__sliding_block_cached__glu_gated_reglu__decode_kernel)/1024
    s_cbranch_scc1 L_pfe_2
    s_lshl_b32 s7, s7, 10
    v_lshl_add_u32 v8, v1, 4, s7
    global_load_dwordx4 v[164:167], v8, s[4:5]
L_pfe_2:
    s_cmp_lg_u32 s3, 8
    s_cbranch_scc1 L_D_noinit
    v_mov_b32 v16, 0
    v_mov_b32 v17, 0
    v_mov_b32 v18, 0
    v_mov_b32 v19, 0
    v_lshlrev_b32 v8, 4, v1
    v_add_u32 v8, 111616, v8
    ds_write_b128 v8, v[16:19]
    ds_write_b128 v8, v[16:19] offset:1024
    s_waitcnt lgkmcnt(0)
L_D_noinit:
    s_barrier
    s_branch L_D
L_A:
    v_lshrrev_b32 v32, 4, v1
    v_and_b32 v33, 15, v1
    v_and_b32 v34, 7, v1
    v_mul_u32_u24 v2, 384, v34
    v_lshrrev_b32 v34, 3, v1
    v_lshl_add_u32 v2, v34, 4, v2
    v_mul_u32_u24 v3, 768, v32
    v_lshl_add_u32 v3, v33, 4, v3
    v_mov_b32 v11, 110592
    v_mov_b32 v0, 1
    s_bfe_u32 s8, s68, 0x20005
    s_lshl_b32 s8, s8, 5
    s_add_u32 s8, s8, s69
    s_mul_i32 s8, s8, 1572864
    s_lshr_b32 s9, s68, 7
    s_mul_i32 s9, s9, 196608
    s_add_u32 s8, s8, s9
    s_mul_i32 s9, s3, 24576
    s_add_u32 s8, s8, s9
    s_add_u32 s8, s8, 1179648
    s_mov_b32 s46, 201326592
    s_mov_b32 s47, 0x00020000
    s_mov_b32 s59, 0x00020000
    s_cmp_ge_u32 s2, 156
    s_cbranch_scc1 L_A_not1
    s_cmp_lt_u32 s2, 60
    s_mov_b32 s4, 7864320
    s_cselect_b32 s58, 4915200, s4
    s_mov_b32 s4, 12288
    s_cselect_b32 s70, 7680, s4
    s_cselect_b32 s4, 0, 60
    s_sub_u32 s71, s2, s4
    s_lshl_b32 s71, s71, 7
    v_lshrrev_b32 v32, 3, v1
    v_mul_lo_u32 v4, v32, s70
    v_lshrrev_b32 v32, 4, v1
    v_lshlrev_b32 v32, 1, v32
    v_and_b32 v33, 7, v1
    v_xor_b32 v32, v32, v33
    v_lshl_add_u32 v4, v32, 4, v4
    s_mul_i32 s72, s3, 80
    s_mul_i32 s73, s72, s70
    s_add_u32 s73, s73, s71
    s_lshl_b32 s72, s72, 7
    s_lshl_b32 s74, s70, 3
    s_waitcnt lgkmcnt(0)
    s_cmp_lt_u32 s2, 60
    s_cselect_b32 s56, s36, s22
    s_cselect_b32 s57, s37, s23
    s_mov_b32 m0, s72
    s_add_u32 s72, s72, 1024
    buffer_load_dwordx4 v4, s[56:59], s73 offen nt lds
    s_add_u32 s73, s73, s74
    s_mov_b32 m0, s72
    s_add_u32 s72, s72, 1024
    buffer_load_dwordx4 v4, s[56:59], s73 offen nt lds
    s_add_u32 s73, s73, s74
    s_mov_b32 m0, s72
    s_add_u32 s72, s72, 1024
    buffer_load_dwordx4 v4, s[56:59], s73 offen nt lds
    s_add_u32 s73, s73, s74
    s_mov_b32 m0, s72
    s_add_u32 s72, s72, 1024
    buffer_load_dwordx4 v4, s[56:59], s73 offen nt lds
    s_add_u32 s73, s73, s74
    s_mov_b32 s44, s18
    s_mov_b32 s45, s19
    s_barrier
    s_cmp_lt_u32 s2, 20
    s_cbranch_scc1 L_A_fast1
    s_waitcnt vmcnt(3)
    s_mov_b32 m0, s72
    s_add_u32 s72, s72, 1024
    buffer_load_dwordx4 v4, s[56:59], s73 offen nt lds
    s_add_u32 s73, s73, s74
    s_waitcnt vmcnt(3)
    s_mov_b32 m0, s72
    s_add_u32 s72, s72, 1024
    buffer_load_dwordx4 v4, s[56:59], s73 offen nt lds
    s_add_u32 s73, s73, s74
    s_waitcnt vmcnt(3)
    s_mov_b32 m0, s72
    s_add_u32 s72, s72, 1024
    buffer_load_dwordx4 v4, s[56:59], s73 offen nt lds
    s_add_u32 s73, s73, s74
    s_waitcnt vmcnt(3)
    s_mov_b32 m0, s72
    s_add_u32 s72, s72, 1024
    buffer_load_dwordx4 v4, s[56:59], s73 offen nt lds
    s_add_u32 s73, s73, s74
    s_waitcnt vmcnt(3)
    s_mov_b32 m0, s72
    s_add_u32 s72, s72, 1024
    buffer_load_dwordx4 v4, s[56:59], s73 offen nt lds
    s_add_u32 s73, s73, s74
    s_waitcnt vmcnt(3)
    s_mov_b32 m0, s72
    s_add_u32 s72, s72, 1024
    buffer_load_dwordx4 v4, s[56:59], s73 offen nt lds
    s_add_u32 s73, s73, s74
    s_branch L_A_k0
L_A_fast1:
    s_mov_b32 m0, s72
    s_add_u32 s72, s72, 1024
    buffer_load_dwordx4 v4, s[56:59], s73 offen nt lds
    s_add_u32 s73, s73, s74
    s_mov_b32 m0, s72
    s_add_u32 s72, s72, 1024
    buffer_load_dwordx4 v4, s[56:59], s73 offen nt lds
    s_add_u32 s73, s73, s74
    s_mov_b32 m0, s72
    s_add_u32 s72, s72, 1024
    buffer_load_dwordx4 v4, s[56:59], s73 offen nt lds
    s_add_u32 s73, s73, s74
    s_mov_b32 m0, s72
    s_add_u32 s72, s72, 1024
    buffer_load_dwordx4 v4, s[56:59], s73 offen nt lds
    s_add_u32 s73, s73, s74
    s_mov_b32 m0, s72
    s_add_u32 s72, s72, 1024
    buffer_load_dwordx4 v4, s[56:59], s73 offen nt lds
    s_add_u32 s73, s73, s74
    s_mov_b32 m0, s72
    s_add_u32 s72, s72, 1024
    buffer_load_dwordx4 v4, s[56:59], s73 offen nt lds
    s_add_u32 s73, s73, s74
    s_waitcnt vmcnt(0)
    s_mov_b64 exec, 1
    ds_add_u32 v11, v0 offset:2880
    s_mov_b64 exec, -1
    s_mov_b32 s5, 0
Lsp_3:
    ds_read_b32 v32, v11 offset:2932
    s_add_u32 s5, s5, 1
    s_waitcnt lgkmcnt(0)
    v_readfirstlane_b32 s4, v32
    s_nop 0
    s_cmp_ge_u32 s4, 4
    s_nop 1
    s_cbranch_scc1 Lspd_4
    s_sleep 1
    s_cmp_lt_u32 s5, 1048576
    s_cbranch_scc1 Lsp_3
Lspd_4:
    s_add_u32 s9, s8, 0
    buffer_load_dwordx4 v[36:39], v2, s[44:47], s9 offen offset:0 nt
    s_add_u32 s9, s8, 0
    buffer_load_dwordx4 v[40:43], v2, s[44:47], s9 offen offset:128 nt
    s_add_u32 s9, s8, 0
    buffer_load_dwordx4 v[44:47], v2, s[44:47], s9 offen offset:256 nt
    s_add_u32 s9, s8, 3072
    buffer_load_dwordx4 v[48:51], v2, s[44:47], s9 offen offset:0 nt
    s_add_u32 s9, s8, 3072
    buffer_load_dwordx4 v[52:55], v2, s[44:47], s9 offen offset:128 nt
    s_add_u32 s9, s8, 3072
    buffer_load_dwordx4 v[56:59], v2, s[44:47], s9 offen offset:256 nt
    s_branch L_A_com
L_A_k0:
    s_waitcnt vmcnt(5)
    s_add_u32 s9, s8, 0
    buffer_load_dwordx4 v[36:39], v2, s[44:47], s9 offen offset:0 nt
    s_waitcnt vmcnt(5)
    s_add_u32 s9, s8, 0
    buffer_load_dwordx4 v[40:43], v2, s[44:47], s9 offen offset:128 nt
    s_waitcnt vmcnt(5)
    s_add_u32 s9, s8, 0
    buffer_load_dwordx4 v[44:47], v2, s[44:47], s9 offen offset:256 nt
    s_waitcnt vmcnt(5)
    s_add_u32 s9, s8, 3072
    buffer_load_dwordx4 v[48:51], v2, s[44:47], s9 offen offset:0 nt
    s_waitcnt vmcnt(5)
    s_add_u32 s9, s8, 3072
    buffer_load_dwordx4 v[52:55], v2, s[44:47], s9 offen offset:128 nt
    s_waitcnt vmcnt(5)
    s_add_u32 s9, s8, 3072
    buffer_load_dwordx4 v[56:59], v2, s[44:47], s9 offen offset:256 nt
    s_waitcnt vmcnt(6)
    s_mov_b64 exec, 1
    ds_add_u32 v11, v0 offset:2880
    s_mov_b64 exec, -1
    s_branch L_A_com
L_A_not1:
    s_waitcnt lgkmcnt(0)
    s_mov_b32 s44, s18
    s_mov_b32 s45, s19
    s_cmp_ge_u32 s2, 236
    s_cbranch_scc1 L_A_clr
    s_add_u32 s9, s8, 0
    buffer_load_dwordx4 v[36:39], v2, s[44:47], s9 offen offset:0 nt
    s_add_u32 s9, s8, 0
    buffer_load_dwordx4 v[40:43], v2, s[44:47], s9 offen offset:128 nt
    s_add_u32 s9, s8, 0
    buffer_load_dwordx4 v[44:47], v2, s[44:47], s9 offen offset:256 nt
    s_add_u32 s9, s8, 3072
    buffer_load_dwordx4 v[48:51], v2, s[44:47], s9 offen offset:0 nt
    s_add_u32 s9, s8, 3072
    buffer_load_dwordx4 v[52:55], v2, s[44:47], s9 offen offset:128 nt
    s_add_u32 s9, s8, 3072
    buffer_load_dwordx4 v[56:59], v2, s[44:47], s9 offen offset:256 nt
    s_barrier
    s_branch L_A_com
L_A_clr:
    s_barrier
    s_mov_b32 s5, 0
Lsp_5:
    ds_read_b32 v32, v11 offset:2932
    s_add_u32 s5, s5, 1
    s_waitcnt lgkmcnt(0)
    v_readfirstlane_b32 s4, v32
    s_nop 0
    s_cmp_ge_u32 s4, 1
    s_nop 1
    s_cbranch_scc1 Lspd_6
    s_sleep 1
    s_cmp_lt_u32 s5, 1048576
    s_cbranch_scc1 Lsp_5
Lspd_6:
    s_add_u32 s9, s8, 0
    buffer_load_dwordx4 v[36:39], v2, s[44:47], s9 offen offset:0 nt
    s_add_u32 s9, s8, 0
    buffer_load_dwordx4 v[40:43], v2, s[44:47], s9 offen offset:128 nt
    s_add_u32 s9, s8, 0
    buffer_load_dwordx4 v[44:47], v2, s[44:47], s9 offen offset:256 nt
    s_add_u32 s9, s8, 3072
    buffer_load_dwordx4 v[48:51], v2, s[44:47], s9 offen offset:0 nt
    s_add_u32 s9, s8, 3072
    buffer_load_dwordx4 v[52:55], v2, s[44:47], s9 offen offset:128 nt
    s_add_u32 s9, s8, 3072
    buffer_load_dwordx4 v[56:59], v2, s[44:47], s9 offen offset:256 nt
L_A_com:
    s_mov_b32 s48, s20
    s_mov_b32 s49, s21
    s_mov_b32 s50, 201326592
    s_mov_b32 s51, 0x00020000
    s_mov_b32 s52, s42
    s_mov_b32 s53, s43
    s_mov_b32 s54, 2097152
    s_mov_b32 s55, 0x00020000
    s_waitcnt vmcnt(5)
    s_add_u32 s9, s8, 6144
    buffer_load_dwordx4 v[60:63], v2, s[44:47], s9 offen offset:0 nt
    s_waitcnt vmcnt(5)
    s_add_u32 s9, s8, 6144
    buffer_load_dwordx4 v[64:67], v2, s[44:47], s9 offen offset:128 nt
    s_waitcnt vmcnt(5)
    s_add_u32 s9, s8, 6144
    buffer_load_dwordx4 v[68:71], v2, s[44:47], s9 offen offset:256 nt
    s_waitcnt vmcnt(5)
    s_add_u32 s9, s8, 9216
    buffer_load_dwordx4 v[72:75], v2, s[44:47], s9 offen offset:0 nt
    s_waitcnt vmcnt(5)
    s_add_u32 s9, s8, 9216
    buffer_load_dwordx4 v[76:79], v2, s[44:47], s9 offen offset:128 nt
    s_waitcnt vmcnt(5)
    s_add_u32 s9, s8, 9216
    buffer_load_dwordx4 v[80:83], v2, s[44:47], s9 offen offset:256 nt
    s_waitcnt vmcnt(5)
    s_add_u32 s9, s8, 12288
    buffer_load_dwordx4 v[84:87], v2, s[44:47], s9 offen offset:0 nt
    s_waitcnt vmcnt(5)
    s_add_u32 s9, s8, 12288
    buffer_load_dwordx4 v[88:91], v2, s[44:47], s9 offen offset:128 nt
    s_waitcnt vmcnt(5)
    s_add_u32 s9, s8, 12288
    buffer_load_dwordx4 v[92:95], v2, s[44:47], s9 offen offset:256 nt
    s_waitcnt vmcnt(5)
    s_add_u32 s9, s8, 15360
    buffer_load_dwordx4 v[96:99], v2, s[44:47], s9 offen offset:0 nt
    s_waitcnt vmcnt(5)
    s_add_u32 s9, s8, 15360
    buffer_load_dwordx4 v[100:103], v2, s[44:47], s9 offen offset:128 nt
    s_waitcnt vmcnt(5)
    s_add_u32 s9, s8, 15360
    buffer_load_dwordx4 v[104:107], v2, s[44:47], s9 offen offset:256 nt
    s_waitcnt vmcnt(5)
    s_add_u32 s9, s8, 18432
    buffer_load_dwordx4 v[108:111], v2, s[44:47], s9 offen offset:0 nt
    s_waitcnt vmcnt(5)
    s_add_u32 s9, s8, 18432
    buffer_load_dwordx4 v[112:115], v2, s[44:47], s9 offen offset:128 nt
    s_waitcnt vmcnt(5)
    s_add_u32 s9, s8, 18432
    buffer_load_dwordx4 v[116:119], v2, s[44:47], s9 offen offset:256 nt
    s_waitcnt vmcnt(5)
    s_add_u32 s9, s8, 21504
    buffer_load_dwordx4 v[120:123], v2, s[44:47], s9 offen offset:0 nt
    s_waitcnt vmcnt(5)
    s_add_u32 s9, s8, 21504
    buffer_load_dwordx4 v[124:127], v2, s[44:47], s9 offen offset:128 nt
    s_waitcnt vmcnt(5)
    s_add_u32 s9, s8, 21504
    buffer_load_dwordx4 v[128:131], v2, s[44:47], s9 offen offset:256 nt
    s_waitcnt vmcnt(5)
    s_add_u32 s9, s8, 0
    buffer_load_dwordx4 v[132:135], v3, s[48:51], s9 offen offset:0 nt
    s_waitcnt vmcnt(5)
    buffer_load_dwordx4 v[136:139], v3, s[48:51], s9 offen offset:256 nt
    s_waitcnt vmcnt(5)
    buffer_load_dwordx4 v[140:143], v3, s[48:51], s9 offen offset:512 nt
    s_waitcnt vmcnt(5)
    s_add_u32 s9, s8, 3072
    buffer_load_dwordx4 v[144:147], v3, s[48:51], s9 offen offset:0 nt
    s_waitcnt vmcnt(5)
    buffer_load_dwordx4 v[148:151], v3, s[48:51], s9 offen offset:256 nt
    s_waitcnt vmcnt(5)
    buffer_load_dwordx4 v[152:155], v3, s[48:51], s9 offen offset:512 nt
    s_waitcnt vmcnt(5)
    s_add_u32 s9, s8, 6144
    buffer_load_dwordx4 v[156:159], v3, s[48:51], s9 offen offset:0 nt
    s_waitcnt vmcnt(5)
    buffer_load_dwordx4 v[160:163], v3, s[48:51], s9 offen offset:256 nt
    s_waitcnt vmcnt(5)
    buffer_load_dwordx4 v[164:167], v3, s[48:51], s9 offen offset:512 nt
    v_and_b32 v32, 1, v1
    v_lshlrev_b32 v32, 4, v32
    v_mov_b32 v33, 0xffff
    v_lshlrev_b32 v33, v32, v33
    v_bfe_u32 v32, v1, 1, 2
    v_cmp_eq_u32 vcc, 0, v32
    s_nop 1
    v_cndmask_b32 v7, 0, v33, vcc
    v_cmp_eq_u32 vcc, 1, v32
    s_nop 1
    v_cndmask_b32 v8, 0, v33, vcc
    v_cmp_eq_u32 vcc, 2, v32
    s_nop 1
    v_cndmask_b32 v9, 0, v33, vcc
    v_cmp_eq_u32 vcc, 3, v32
    s_nop 1
    v_cndmask_b32 v10, 0, v33, vcc
    v_lshrrev_b32 v32, 4, v1
    v_lshlrev_b32 v32, 5, v32
    v_and_b32 v33, 1, v1
    v_lshl_add_u32 v32, v33, 4, v32
    v_add_u32 v34, 111104, v32
    s_mov_b32 s75, 0
    s_mov_b32 s76, 0
    s_mov_b32 s77, 0
    s_cmp_ge_u32 s2, 236
    s_cbranch_scc1 L_A_s6
    s_cmp_ge_u32 s2, 156
    s_cbranch_scc1 L_A_s4
    s_cmp_lt_u32 s2, 20
    s_cbranch_scc1 L_A_sdone
    s_cmp_ge_u32 s2, 68
    s_cbranch_scc1 L_A_sdone
    s_cmp_lt_u32 s2, 44
    s_cselect_b32 s56, s28, s30
    s_cselect_b32 s57, s29, s31
    s_mov_b32 s58, 1966080
    s_mov_b32 s70, 3072
    s_cselect_b32 s4, 20, 44
    s_sub_u32 s71, s2, s4
    s_lshl_b32 s71, s71, 7
    v_lshrrev_b32 v32, 3, v1
    v_mul_lo_u32 v4, v32, s70
    v_lshrrev_b32 v32, 4, v1
    v_lshlrev_b32 v32, 1, v32
    v_and_b32 v33, 7, v1
    v_xor_b32 v32, v32, v33
    v_lshl_add_u32 v4, v32, 4, v4
    s_mul_i32 s72, s3, 80
    s_mul_i32 s73, s72, s70
    s_add_u32 s73, s73, s71
    s_lshl_b32 s72, s72, 7
    s_lshl_b32 s74, s70, 3
    s_mov_b32 s75, 10
    s_mov_b32 s76, 0
    s_branch L_A_sdone
L_A_s4:
    s_mov_b32 s56, s24
    s_mov_b32 s57, s25
    s_mov_b32 s58, 7864320
    s_mov_b32 s70, 1280
    s_and_b32 s5, s68, 7
    s_sub_u32 s6, s68, 160
    s_lshr_b32 s6, s6, 3
    s_mul_i32 s71, s5, 983040
    s_lshl_b32 s6, s6, 7
    s_add_u32 s71, s71, s6
    v_lshrrev_b32 v32, 3, v1
    v_mul_lo_u32 v4, v32, s70
    v_lshrrev_b32 v32, 4, v1
    v_lshlrev_b32 v32, 1, v32
    v_and_b32 v33, 7, v1
    v_xor_b32 v32, v32, v33
    v_lshl_add_u32 v4, v32, 4, v4
    s_mul_i32 s72, s3, 96
    s_mul_i32 s73, s72, s70
    s_add_u32 s73, s73, s71
    s_lshl_b32 s72, s72, 7
    s_lshl_b32 s74, s70, 3
    s_mov_b32 s75, 12
    s_mov_b32 s76, 12
    s_branch L_A_sdone
L_A_s6:
    s_mov_b32 s56, s32
    s_mov_b32 s57, s33
    s_mov_b32 s58, 1966080
    s_mov_b32 s70, 1280
    s_sub_u32 s71, s2, 236
    s_lshl_b32 s71, s71, 6
    v_lshrrev_b32 v32, 2, v1
    v_mul_lo_u32 v4, v32, s70
    v_bfe_u32 v32, v1, 4, 1
    v_lshlrev_b32 v32, 1, v32
    v_and_b32 v33, 3, v1
    v_xor_b32 v32, v32, v33
    v_lshl_add_u32 v4, v32, 4, v4
    s_mul_i32 s72, s3, 192
    s_mul_i32 s73, s72, s70
    s_add_u32 s73, s73, s71
    s_lshl_b32 s72, s72, 6
    s_lshl_b32 s74, s70, 4
    s_mov_b32 s75, 12
    s_mov_b32 s76, 2
L_A_sdone:
L_A_dl_7:
    s_cmp_ge_u32 s77, s76
    s_cbranch_scc1 L_A_dld_8
    s_waitcnt vmcnt(5)
    s_mov_b32 m0, s72
    s_add_u32 s72, s72, 1024
    buffer_load_dwordx4 v4, s[56:59], s73 offen nt lds
    s_add_u32 s73, s73, s74
    s_add_u32 s77, s77, 1
    s_branch L_A_dl_7
L_A_dld_8:
    s_mov_b32 s5, 0
Lsp_9:
    ds_read_b32 v32, v11 offset:2888
    s_add_u32 s5, s5, 1
    s_waitcnt lgkmcnt(0)
    v_readfirstlane_b32 s4, v32
    s_nop 0
    s_cmp_ge_u32 s4, 1
    s_nop 1
    s_cbranch_scc1 Lspd_10
    s_sleep 2
    s_cmp_lt_u32 s5, 1048576
    s_cbranch_scc1 Lsp_9
Lspd_10:
    ds_read_b128 v[12:15], v34 offset:0
    ds_read_b128 v[16:19], v34 offset:128
    ds_read_b128 v[20:23], v34 offset:256
    s_waitcnt lgkmcnt(0)
    v_mfma_f32_16x16x32_bf16 v[24:27], v[12:15], v[36:39], 0
    v_mfma_f32_16x16x32_bf16 v[24:27], v[16:19], v[40:43], v[24:27]
    v_mfma_f32_16x16x32_bf16 v[24:27], v[20:23], v[44:47], v[24:27]
    v_mfma_f32_16x16x32_bf16 v[28:31], v[12:15], v[48:51], 0
    v_mfma_f32_16x16x32_bf16 v[28:31], v[16:19], v[52:55], v[28:31]
    v_mfma_f32_16x16x32_bf16 v[28:31], v[20:23], v[56:59], v[28:31]
    s_nop 4
    v_add_f32_dpp v5, v25, v24 row_ror:8 row_mask:0x1 bank_mask:0x3
    s_waitcnt vmcnt(7)
    s_add_u32 s9, s8, 9216
    buffer_load_dwordx4 v[36:39], v3, s[48:51], s9 offen offset:0 nt
    s_waitcnt vmcnt(7)
    buffer_load_dwordx4 v[40:43], v3, s[48:51], s9 offen offset:256 nt
    s_waitcnt vmcnt(7)
    buffer_load_dwordx4 v[44:47], v3, s[48:51], s9 offen offset:512 nt
    v_mfma_f32_16x16x32_bf16 v[24:27], v[12:15], v[60:63], 0
    v_mfma_f32_16x16x32_bf16 v[24:27], v[16:19], v[64:67], v[24:27]
    v_mfma_f32_16x16x32_bf16 v[24:27], v[20:23], v[68:71], v[24:27]
    v_add_f32_dpp v5, v28, v29 row_ror:8 row_mask:0x1 bank_mask:0xc
    s_waitcnt vmcnt(7)
    s_add_u32 s9, s8, 12288
    buffer_load_dwordx4 v[48:51], v3, s[48:51], s9 offen offset:0 nt
    s_waitcnt vmcnt(7)
    buffer_load_dwordx4 v[52:55], v3, s[48:51], s9 offen offset:256 nt
    s_waitcnt vmcnt(7)
    buffer_load_dwordx4 v[56:59], v3, s[48:51], s9 offen offset:512 nt
    v_mfma_f32_16x16x32_bf16 v[28:31], v[12:15], v[72:75], 0
    v_mfma_f32_16x16x32_bf16 v[28:31], v[16:19], v[76:79], v[28:31]
    v_mfma_f32_16x16x32_bf16 v[28:31], v[20:23], v[80:83], v[28:31]
    v_add_f32_dpp v5, v25, v24 row_ror:8 row_mask:0x2 bank_mask:0x3
    s_waitcnt vmcnt(7)
    s_add_u32 s9, s8, 15360
    buffer_load_dwordx4 v[60:63], v3, s[48:51], s9 offen offset:0 nt
    s_waitcnt vmcnt(7)
    buffer_load_dwordx4 v[64:67], v3, s[48:51], s9 offen offset:256 nt
    v_mfma_f32_16x16x32_bf16 v[24:27], v[12:15], v[84:87], 0
    v_mfma_f32_16x16x32_bf16 v[24:27], v[16:19], v[88:91], v[24:27]
    v_mfma_f32_16x16x32_bf16 v[24:27], v[20:23], v[92:95], v[24:27]
    v_add_f32_dpp v5, v28, v29 row_ror:8 row_mask:0x2 bank_mask:0xc
    v_mfma_f32_16x16x32_bf16 v[28:31], v[12:15], v[96:99], 0
    v_mfma_f32_16x16x32_bf16 v[28:31], v[16:19], v[100:103], v[28:31]
    v_mfma_f32_16x16x32_bf16 v[28:31], v[20:23], v[104:107], v[28:31]
    s_nop 3
    v_add_f32_dpp v5, v25, v24 row_ror:8 row_mask:0x4 bank_mask:0x3
    v_mfma_f32_16x16x32_bf16 v[24:27], v[12:15], v[108:111], 0
    v_mfma_f32_16x16x32_bf16 v[24:27], v[16:19], v[112:115], v[24:27]
    v_mfma_f32_16x16x32_bf16 v[24:27], v[20:23], v[116:119], v[24:27]
    v_add_f32_dpp v5, v28, v29 row_ror:8 row_mask:0x4 bank_mask:0xc
    v_mfma_f32_16x16x32_bf16 v[28:31], v[12:15], v[120:123], 0
    v_mfma_f32_16x16x32_bf16 v[28:31], v[16:19], v[124:127], v[28:31]
    v_mfma_f32_16x16x32_bf16 v[28:31], v[20:23], v[128:131], v[28:31]
    s_nop 3
    v_add_f32_dpp v5, v25, v24 row_ror:8 row_mask:0x8 bank_mask:0x3
    s_nop 2
    v_add_f32_dpp v5, v28, v29 row_ror:8 row_mask:0x8 bank_mask:0xc
    v_cvt_pk_bf16_f32 v5, v5, v5
    v_lshlrev_b32 v5, 16, v5
    v_mul_f32 v5, 0x3d93cd3a, v5
    v_cvt_pk_bf16_f32 v5, v5, v5
    v_lshlrev_b32 v5, 16, v5
    v_mov_b32 v32, v5
    s_nop 1
    v_max_f32_dpp v32, v32, v32 quad_perm:[1,0,3,2] row_mask:0xf bank_mask:0xf
    s_nop 1
    v_max_f32_dpp v32, v32, v32 quad_perm:[2,3,0,1] row_mask:0xf bank_mask:0xf
    s_nop 1
    v_max_f32_dpp v32, v32, v32 row_half_mirror row_mask:0xf bank_mask:0xf
    s_nop 1
    v_max_f32_dpp v32, v32, v32 row_mirror row_mask:0xf bank_mask:0xf
    s_nop 1
    v_max_f32_dpp v32, v32, v32 row_bcast:15 row_mask:0xa bank_mask:0xf
    s_nop 1
    v_max_f32_dpp v32, v32, v32 row_bcast:31 row_mask:0xc bank_mask:0xf
    s_nop 0
    v_readlane_b32 s10, v32, 63
    s_nop 1
    v_mov_b32 v32, s10
    s_lshl_b32 s11, s3, 2
    v_add_u32 v33, s11, v11
    s_mov_b64 exec, 1
    ds_write_b32 v33, v32 offset:2816
    ds_add_u32 v11, v0 offset:2892
    s_mov_b64 exec, -1
    v_and_b32 v32, 15, v1
    v_lshlrev_b32 v32, 1, v32
    v_bfe_u32 v33, v1, 4, 1
    v_add_u32 v32, v32, v33
    v_lshlrev_b32 v32, 4, v32
    v_lshrrev_b32 v33, 5, v1
    s_mul_i32 s4, s3, 1536
    s_add_u32 s4, s4, 114688
    v_add_u32 v32, s4, v32
    v_lshl_add_u32 v128, v33, 10, v32
    v_add_u32 v129, 512, v32
    s_mov_b32 s12, 0x00ff00ff
    s_mov_b32 s13, 0xff00ff00
    v_lshlrev_b32 v130, 4, v1
    v_add_u32 v130, 114688, v130
    v_lshrrev_b32 v32, 3, v1
    v_lshlrev_b32 v131, 6, v32
    v_and_b32 v32, 3, v1
    v_lshl_add_u32 v131, v32, 4, v131
    v_bfe_u32 v32, v1, 2, 1
    v_lshl_add_u32 v131, v32, 3, v131
    s_lshr_b32 s14, s68, 5
    s_lshl_b32 s15, s69, 3
    s_add_u32 s15, s15, s14
    s_lshl_b32 s15, s15, 9
    s_add_u32 s15, s15, 81920
    s_add_u32 s14, s15, 245760
    s_waitcnt vmcnt(7)
    buffer_load_dwordx4 v[68:71], v3, s[48:51], s9 offen offset:512 nt
    s_cmp_eq_u32 s75, 0
    s_cbranch_scc1 L_A_ns2
    s_cmp_lg_u32 s77, s75
    s_cbranch_scc1 L_A_ns2
    s_mov_b64 exec, 1
    ds_add_u32 v11, v0 offset:2884
    s_mov_b64 exec, -1
    s_mov_b32 s75, 0
L_A_ns2:
    s_mov_b32 s5, 0
Lsp_11:
    ds_read_b32 v32, v11 offset:2892
    s_add_u32 s5, s5, 1
    s_waitcnt lgkmcnt(0)
    v_readfirstlane_b32 s4, v32
    s_nop 0
    s_cmp_ge_u32 s4, 8
    s_nop 1
    s_cbranch_scc1 Lspd_12
    s_sleep 1
    s_cmp_lt_u32 s5, 1048576
    s_cbranch_scc1 Lsp_11
Lspd_12:
    ds_read_b128 v[24:27], v11 offset:2816
    ds_read_b128 v[28:31], v11 offset:2832
    s_waitcnt lgkmcnt(0)
    v_max3_f32 v32, v24, v25, v26
    v_max3_f32 v32, v32, v27, v28
    v_max3_f32 v32, v32, v29, v30
    v_max_f32 v24, v32, v31
    v_sub_f32 v5, v5, v24
    v_mul_f32 v5, 0x3fb8aa3b, v5
    v_exp_f32 v5, v5
    s_nop 0
    v_cvt_pk_bf16_f32 v6, v5, v5
    v_and_b32 v32, 7, v1
    v_lshlrev_b32 v32, 5, v32
    v_lshrrev_b32 v33, 3, v1
    v_lshl_add_u32 v32, v33, 2, v32
    ds_bpermute_b32 v6, v32, v6
    v_add_f32_dpp v5, v5, v5 quad_perm:[1,0,3,2] row_mask:0xf bank_mask:0xf
    s_nop 1
    v_add_f32_dpp v5, v5, v5 quad_perm:[2,3,0,1] row_mask:0xf bank_mask:0xf
    s_nop 1
    v_add_f32_dpp v5, v5, v5 row_half_mirror row_mask:0xf bank_mask:0xf
    s_nop 1
    v_add_f32_dpp v5, v5, v5 row_mirror row_mask:0xf bank_mask:0xf
    s_nop 1
    v_add_f32_dpp v5, v5, v5 row_bcast:15 row_mask:0xa bank_mask:0xf
    s_nop 1
    v_add_f32_dpp v5, v5, v5 row_bcast:31 row_mask:0xc bank_mask:0xf
    s_nop 0
    v_readlane_b32 s10, v5, 63
    s_nop 1
    v_mov_b32 v32, s10
    s_mov_b64 exec, 1
    ds_add_f32 v11, v32 offset:2848
    ds_add_u32 v11, v0 offset:2896
    s_mov_b64 exec, -1
    s_waitcnt vmcnt(7)
    s_add_u32 s9, s8, 18432
    buffer_load_dwordx4 v[72:75], v3, s[48:51], s9 offen offset:0 nt
    s_waitcnt lgkmcnt(0)
    v_mov_b32_dpp v32, v6 row_newbcast:0 row_mask:0xf bank_mask:0x3
    s_nop 1
    v_mov_b32_dpp v32, v6 row_newbcast:8 row_mask:0xf bank_mask:0xc
    v_and_b32 v96, v32, v7
    v_and_b32 v97, v32, v8
    v_and_b32 v98, v32, v9
    v_and_b32 v99, v32, v10
    v_mov_b32_dpp v33, v6 row_newbcast:1 row_mask:0xf bank_mask:0x3
    s_nop 1
    v_mov_b32_dpp v33, v6 row_newbcast:9 row_mask:0xf bank_mask:0xc
    v_and_b32 v100, v33, v7
    v_and_b32 v101, v33, v8
    v_and_b32 v102, v33, v9
    v_and_b32 v103, v33, v10
    v_mov_b32_dpp v32, v6 row_newbcast:2 row_mask:0xf bank_mask:0x3
    s_nop 1
    v_mov_b32_dpp v32, v6 row_newbcast:10 row_mask:0xf bank_mask:0xc
    v_and_b32 v104, v32, v7
    v_and_b32 v105, v32, v8
    v_and_b32 v106, v32, v9
    v_and_b32 v107, v32, v10
    v_mov_b32_dpp v33, v6 row_newbcast:3 row_mask:0xf bank_mask:0x3
    s_nop 1
    v_mov_b32_dpp v33, v6 row_newbcast:11 row_mask:0xf bank_mask:0xc
    v_and_b32 v108, v33, v7
    v_and_b32 v109, v33, v8
    v_and_b32 v110, v33, v9
    v_and_b32 v111, v33, v10
    v_mov_b32_dpp v32, v6 row_newbcast:4 row_mask:0xf bank_mask:0x3
    s_nop 1
    v_mov_b32_dpp v32, v6 row_newbcast:12 row_mask:0xf bank_mask:0xc
    v_and_b32 v112, v32, v7
    v_and_b32 v113, v32, v8
    v_and_b32 v114, v32, v9
    v_and_b32 v115, v32, v10
    v_mov_b32_dpp v33, v6 row_newbcast:5 row_mask:0xf bank_mask:0x3
    s_nop 1
    v_mov_b32_dpp v33, v6 row_newbcast:13 row_mask:0xf bank_mask:0xc
    v_and_b32 v116, v33, v7
    v_and_b32 v117, v33, v8
    v_and_b32 v118, v33, v9
    v_and_b32 v119, v33, v10
    v_mov_b32_dpp v32, v6 row_newbcast:6 row_mask:0xf bank_mask:0x3
    s_nop 1
    v_mov_b32_dpp v32, v6 row_newbcast:14 row_mask:0xf bank_mask:0xc
    v_and_b32 v120, v32, v7
    v_and_b32 v121, v32, v8
    v_and_b32 v122, v32, v9
    v_and_b32 v123, v32, v10
    v_mov_b32_dpp v33, v6 row_newbcast:7 row_mask:0xf bank_mask:0x3
    s_nop 1
    v_mov_b32_dpp v33, v6 row_newbcast:15 row_mask:0xf bank_mask:0xc
    v_and_b32 v124, v33, v7
    v_and_b32 v125, v33, v8
    v_and_b32 v126, v33, v9
    v_and_b32 v127, v33, v10
    v_mfma_f32_16x16x32_bf16 v[12:15], v[96:99], v[132:135], 0
    v_mfma_f32_16x16x32_bf16 v[16:19], v[96:99], v[136:139], 0
    v_mfma_f32_16x16x32_bf16 v[20:23], v[96:99], v[140:143], 0
    v_mfma_f32_16x16x32_bf16 v[12:15], v[100:103], v[144:147], v[12:15]
    v_mfma_f32_16x16x32_bf16 v[16:19], v[100:103], v[148:151], v[16:19]
    v_mfma_f32_16x16x32_bf16 v[20:23], v[100:103], v[152:155], v[20:23]
    v_mfma_f32_16x16x32_bf16 v[12:15], v[104:107], v[156:159], v[12:15]
    v_mfma_f32_16x16x32_bf16 v[16:19], v[104:107], v[160:163], v[16:19]
    v_mfma_f32_16x16x32_bf16 v[20:23], v[104:107], v[164:167], v[20:23]
    s_waitcnt vmcnt(7)
    v_mfma_f32_16x16x32_bf16 v[12:15], v[108:111], v[36:39], v[12:15]
    v_mfma_f32_16x16x32_bf16 v[16:19], v[108:111], v[40:43], v[16:19]
    v_mfma_f32_16x16x32_bf16 v[20:23], v[108:111], v[44:47], v[20:23]
    buffer_load_dwordx4 v[76:79], v3, s[48:51], s9 offen offset:256 nt
    s_waitcnt vmcnt(7)
    buffer_load_dwordx4 v[80:83], v3, s[48:51], s9 offen offset:512 nt
    s_waitcnt vmcnt(7)
    s_add_u32 s9, s8, 21504
    buffer_load_dwordx4 v[84:87], v3, s[48:51], s9 offen offset:0 nt
    s_waitcnt vmcnt(7)
    v_mfma_f32_16x16x32_bf16 v[12:15], v[112:115], v[48:51], v[12:15]
    v_mfma_f32_16x16x32_bf16 v[16:19], v[112:115], v[52:55], v[16:19]
    v_mfma_f32_16x16x32_bf16 v[20:23], v[112:115], v[56:59], v[20:23]
    buffer_load_dwordx4 v[88:91], v3, s[48:51], s9 offen offset:256 nt
    s_waitcnt vmcnt(7)
    buffer_load_dwordx4 v[92:95], v3, s[48:51], s9 offen offset:512 nt
    s_waitcnt vmcnt(7)
    s_waitcnt vmcnt(6)
    v_mfma_f32_16x16x32_bf16 v[12:15], v[116:119], v[60:63], v[12:15]
    v_mfma_f32_16x16x32_bf16 v[16:19], v[116:119], v[64:67], v[16:19]
    v_mfma_f32_16x16x32_bf16 v[20:23], v[116:119], v[68:71], v[20:23]
    s_waitcnt vmcnt(5)
    s_waitcnt vmcnt(4)
    s_waitcnt vmcnt(3)
    v_mfma_f32_16x16x32_bf16 v[12:15], v[120:123], v[72:75], v[12:15]
    v_mfma_f32_16x16x32_bf16 v[16:19], v[120:123], v[76:79], v[16:19]
    v_mfma_f32_16x16x32_bf16 v[20:23], v[120:123], v[80:83], v[20:23]
    s_waitcnt vmcnt(2)
    s_waitcnt vmcnt(1)
    s_waitcnt vmcnt(0)
    v_mfma_f32_16x16x32_bf16 v[12:15], v[124:127], v[84:87], v[12:15]
    v_mfma_f32_16x16x32_bf16 v[16:19], v[124:127], v[88:91], v[16:19]
    v_mfma_f32_16x16x32_bf16 v[20:23], v[124:127], v[92:95], v[20:23]
    s_nop 7
    v_mov_b32_dpp v12, v20 quad_perm:[0,1,2,3] row_mask:0xc bank_mask:0xf
    v_mov_b32_dpp v13, v21 quad_perm:[0,1,2,3] row_mask:0xc bank_mask:0xf
    v_mov_b32_dpp v14, v22 quad_perm:[0,1,2,3] row_mask:0xc bank_mask:0xf
    v_mov_b32_dpp v15, v23 quad_perm:[0,1,2,3] row_mask:0xc bank_mask:0xf
    s_mov_b64 exec, s[12:13]
    ds_write_b128 v129, v[16:19]
    s_mov_b64 exec, -1
    ds_write_b128 v128, v[12:15]
    s_mov_b64 exec, 1
    ds_add_rtn_u32 v32, v11, v0 offset:2900
    s_mov_b64 exec, -1
    s_waitcnt lgkmcnt(0)
    v_readfirstlane_b32 s4, v32
    s_nop 0
    s_cmp_lg_u32 s4, 7
    s_nop 1
    s_cbranch_scc1 L_A_nopub_13
    ds_read_b32 v25, v11 offset:2848
    ds_read_b128 v[36:39], v130 offset:0
    ds_read_b128 v[40:43], v130 offset:768
    ds_read_b128 v[44:47], v130 offset:1536
    ds_read_b128 v[48:51], v130 offset:2304
    ds_read_b128 v[52:55], v130 offset:3072
    ds_read_b128 v[56:59], v130 offset:3840
    ds_read_b128 v[60:63], v130 offset:4608
    ds_read_b128 v[64:67], v130 offset:5376
    ds_read_b128 v[68:71], v130 offset:6144
    ds_read_b128 v[72:75], v130 offset:6912
    ds_read_b128 v[76:79], v130 offset:7680
    ds_read_b128 v[80:83], v130 offset:8448
    ds_read_b128 v[84:87], v130 offset:9216
    ds_read_b128 v[88:91], v130 offset:9984
    ds_read_b128 v[92:95], v130 offset:10752
    ds_read_b128 v[96:99], v130 offset:11520
    s_waitcnt lgkmcnt(14)
    v_pk_add_f32 v[36:37], v[36:37], v[40:41]
    v_pk_add_f32 v[38:39], v[38:39], v[42:43]
    s_waitcnt lgkmcnt(13)
    v_pk_add_f32 v[36:37], v[36:37], v[44:45]
    v_pk_add_f32 v[38:39], v[38:39], v[46:47]
    s_waitcnt lgkmcnt(12)
    v_pk_add_f32 v[36:37], v[36:37], v[48:49]
    v_pk_add_f32 v[38:39], v[38:39], v[50:51]
    s_waitcnt lgkmcnt(11)
    v_pk_add_f32 v[36:37], v[36:37], v[52:53]
    v_pk_add_f32 v[38:39], v[38:39], v[54:55]
    s_waitcnt lgkmcnt(10)
    v_pk_add_f32 v[36:37], v[36:37], v[56:57]
    v_pk_add_f32 v[38:39], v[38:39], v[58:59]
    s_waitcnt lgkmcnt(9)
    v_pk_add_f32 v[36:37], v[36:37], v[60:61]
    v_pk_add_f32 v[38:39], v[38:39], v[62:63]
    s_waitcnt lgkmcnt(8)
    v_pk_add_f32 v[36:37], v[36:37], v[64:65]
    v_pk_add_f32 v[38:39], v[38:39], v[66:67]
    s_waitcnt lgkmcnt(7)
    v_pk_add_f32 v[36:37], v[36:37], v[68:69]
    v_pk_add_f32 v[38:39], v[38:39], v[70:71]
    s_waitcnt lgkmcnt(6)
    v_pk_add_f32 v[36:37], v[36:37], v[72:73]
    v_pk_add_f32 v[38:39], v[38:39], v[74:75]
    s_waitcnt lgkmcnt(5)
    v_pk_add_f32 v[36:37], v[36:37], v[76:77]
    v_pk_add_f32 v[38:39], v[38:39], v[78:79]
    s_waitcnt lgkmcnt(4)
    v_pk_add_f32 v[36:37], v[36:37], v[80:81]
    v_pk_add_f32 v[38:39], v[38:39], v[82:83]
    s_waitcnt lgkmcnt(3)
    v_pk_add_f32 v[36:37], v[36:37], v[84:85]
    v_pk_add_f32 v[38:39], v[38:39], v[86:87]
    s_waitcnt lgkmcnt(2)
    v_pk_add_f32 v[36:37], v[36:37], v[88:89]
    v_pk_add_f32 v[38:39], v[38:39], v[90:91]
    s_waitcnt lgkmcnt(1)
    v_pk_add_f32 v[36:37], v[36:37], v[92:93]
    v_pk_add_f32 v[38:39], v[38:39], v[94:95]
    s_waitcnt lgkmcnt(0)
    v_pk_add_f32 v[36:37], v[36:37], v[96:97]
    v_pk_add_f32 v[38:39], v[38:39], v[98:99]
    v_cvt_pk_bf16_f32 v12, v36, v37
    v_cvt_pk_bf16_f32 v13, v38, v39
    s_nop 0
    v_mov_b32_dpp v12, v24 quad_perm:[0,1,2,3] row_mask:0x8 bank_mask:0xf
    v_mov_b32_dpp v13, v25 quad_perm:[0,1,2,3] row_mask:0x8 bank_mask:0xf
    v_min_u32 v12, -2, v12
    v_min_u32 v13, -2, v13
    s_mov_b32 s4, -1
    s_mov_b32 s5, 0x1ffff
    s_mov_b64 exec, s[4:5]
    buffer_store_dwordx2 v[12:13], v131, s[52:55], s14 offen
    buffer_store_dwordx2 v[12:13], v131, s[52:55], s15 offen sc1
    s_mov_b64 exec, 1
    ds_add_u32 v11, v0 offset:2940
    s_mov_b64 exec, -1
L_A_nopub_13:
    s_cmp_eq_u32 s75, 0
    s_cbranch_scc1 L_A_roles
    s_cmp_ge_u32 s2, 156
    s_cbranch_scc1 L_A_nf
    s_mov_b32 s5, 0
Lsp_14:
    ds_read_b32 v32, v11 offset:2908
    s_add_u32 s5, s5, 1
    s_waitcnt lgkmcnt(0)
    v_readfirstlane_b32 s4, v32
    s_nop 0
    s_cmp_ge_u32 s4, 4
    s_nop 1
    s_cbranch_scc1 Lspd_15
    s_sleep 1
    s_cmp_lt_u32 s5, 1048576
    s_cbranch_scc1 Lsp_14
Lspd_15:
L_A_nf:
L_A_dl2:
    s_cmp_ge_u32 s77, s75
    s_cbranch_scc1 L_A_dl2d
    s_waitcnt vmcnt(3)
    s_mov_b32 m0, s72
    s_add_u32 s72, s72, 1024
    buffer_load_dwordx4 v4, s[56:59], s73 offen nt lds
    s_add_u32 s73, s73, s74
    s_add_u32 s77, s77, 1
    s_branch L_A_dl2
L_A_dl2d:
    s_waitcnt vmcnt(0)
    s_mov_b64 exec, 1
    ds_add_u32 v11, v0 offset:2884
    s_mov_b64 exec, -1
L_A_roles:
    s_cmp_ge_u32 s2, 236
    s_cbranch_scc1 L_A_t6
    s_cmp_ge_u32 s2, 68
    s_cbranch_scc1 L_A_end
    s_cmp_lt_u32 s2, 20
    s_cbranch_scc1 L_A_end
    s_cmp_ge_u32 s3, 4
    s_cbranch_scc1 L_A_end
    v_lshlrev_b32 v4, 4, v1
    v_lshlrev_b32 v3, 2, v1
    v_lshrrev_b32 v7, 3, v1
    v_lshlrev_b32 v5, 6, v7
    v_and_b32 v7, 3, v1
    v_lshl_add_u32 v5, v7, 4, v5
    v_bfe_u32 v7, v1, 2, 1
    v_lshl_add_u32 v5, v7, 3, v5
    v_lshrrev_b32 v8, 1, v1
    v_lshrrev_b32 v7, 3, v8
    v_lshlrev_b32 v6, 6, v7
    v_and_b32 v7, 3, v8
    v_lshl_add_u32 v6, v7, 4, v6
    v_bfe_u32 v7, v8, 2, 1
    v_lshl_add_u32 v6, v7, 3, v6
    v_and_b32 v7, 1, v1
    v_lshl_add_u32 v6, v7, 2, v6
    v_add_u32 v6, 1024, v6
    v_lshrrev_b32 v7, 2, v1
    v_lshlrev_b32 v5, 6, v7
    v_and_b32 v7, 1, v1
    v_lshl_add_u32 v5, v7, 5, v5
    v_bfe_u32 v7, v1, 1, 1
    v_lshl_add_u32 v5, v7, 3, v5
    s_mul_i32 s6, s3, 1344
    s_add_u32 s6, s6, 98304
    v_add_u32 v5, s6, v5
    v_add_u32 v6, s6, v6
    s_mov_b32 s60, s16
    s_mov_b32 s61, s17
    s_mov_b32 s62, 5120
    s_mov_b32 s63, 0x00020000
    s_mul_i32 s8, s3, 1280
    buffer_load_dwordx4 v[12:15], v4, s[60:63], s8 offen
    buffer_load_dword v16, v3, s[60:63], s8 offen offset:1024
    v_lshrrev_b32 v7, 2, v1
    v_lshlrev_b32 v9, 7, v7
    v_and_b32 v7, 3, v1
    v_lshl_add_u32 v9, v7, 3, v9
    v_lshrrev_b32 v7, 3, v1
    v_lshlrev_b32 v10, 7, v7
    v_and_b32 v7, 7, v1
    v_lshl_add_u32 v10, v7, 2, v10
    v_add_u32 v10, 4096, v10
    v_lshrrev_b32 v7, 1, v1
    v_lshlrev_b32 v9, 7, v7
    v_and_b32 v7, 1, v1
    v_lshl_add_u32 v9, v7, 4, v9
    s_lshl_b32 s8, s3, 5
    s_add_u32 s9, s8, 10240
    s_add_u32 s10, s8, 15360
    s_add_u32 s11, s8, 20480
    s_mov_b32 s5, 0
Lpl_16:
    buffer_load_dwordx4 v[18:21], v9, s[52:55], s9 offen sc1
    buffer_load_dword v22, v10, s[52:55], s9 offen sc1
    buffer_load_dwordx4 v[24:27], v9, s[52:55], s10 offen sc1
    buffer_load_dword v28, v10, s[52:55], s10 offen sc1
    buffer_load_dwordx4 v[30:33], v9, s[52:55], s11 offen sc1
    buffer_load_dword v34, v10, s[52:55], s11 offen sc1
    s_add_u32 s5, s5, 1
    s_waitcnt vmcnt(0)
    v_max3_u32 v7, v18, v19, v20
    v_max3_u32 v7, v7, v21, v22
    v_max3_u32 v7, v7, v24, v25
    v_max3_u32 v7, v7, v26, v27
    v_max3_u32 v7, v7, v28, v30
    v_max3_u32 v7, v7, v31, v32
    v_max3_u32 v7, v7, v33, v34
    v_cmp_eq_u32 vcc, -1, v7
    s_nop 3
    s_cbranch_vccz Lpld_17
    s_sleep 2
    s_cmp_lt_u32 s5, 1048576
    s_cbranch_scc1 Lpl_16
Lpld_17:
    v_lshlrev_b32 v144, 16, v12
    v_and_b32 v145, 0xffff0000, v12
    v_lshlrev_b32 v146, 16, v13
    v_and_b32 v147, 0xffff0000, v13
    v_lshlrev_b32 v148, 16, v14
    v_and_b32 v149, 0xffff0000, v14
    v_lshlrev_b32 v150, 16, v15
    v_and_b32 v151, 0xffff0000, v15
    v_lshlrev_b32 v152, 16, v16
    v_and_b32 v153, 0xffff0000, v16
    v_lshlrev_b32 v154, 16, v18
    v_and_b32 v155, 0xffff0000, v18
    v_lshlrev_b32 v156, 16, v19
    v_and_b32 v157, 0xffff0000, v19
    v_lshlrev_b32 v158, 16, v20
    v_and_b32 v159, 0xffff0000, v20
    v_lshlrev_b32 v160, 16, v21
    v_and_b32 v161, 0xffff0000, v21
    v_lshlrev_b32 v162, 16, v22
    v_and_b32 v163, 0xffff0000, v22
    v_lshlrev_b32 v46, 16, v30
    v_and_b32 v47, 0xffff0000, v30
    v_lshlrev_b32 v48, 16, v31
    v_and_b32 v49, 0xffff0000, v31
    v_lshlrev_b32 v50, 16, v32
    v_and_b32 v51, 0xffff0000, v32
    v_lshlrev_b32 v52, 16, v33
    v_and_b32 v53, 0xffff0000, v33
    v_lshlrev_b32 v54, 16, v34
    v_and_b32 v55, 0xffff0000, v34
    v_add_f32 v46, 1.0, v46
    v_add_f32 v47, 1.0, v47
    v_add_f32 v48, 1.0, v48
    v_add_f32 v49, 1.0, v49
    v_add_f32 v50, 1.0, v50
    v_add_f32 v51, 1.0, v51
    v_add_f32 v52, 1.0, v52
    v_add_f32 v53, 1.0, v53
    v_add_f32 v54, 1.0, v54
    v_add_f32 v55, 1.0, v55
    v_cvt_pk_bf16_f32 v56, v46, v47
    v_cvt_pk_bf16_f32 v57, v48, v49
    v_cvt_pk_bf16_f32 v58, v50, v51
    v_cvt_pk_bf16_f32 v59, v52, v53
    v_cvt_pk_bf16_f32 v60, v54, v55
    v_lshlrev_b32 v46, 16, v56
    v_and_b32 v47, 0xffff0000, v56
    v_lshlrev_b32 v48, 16, v57
    v_and_b32 v49, 0xffff0000, v57
    v_lshlrev_b32 v50, 16, v58
    v_and_b32 v51, 0xffff0000, v58
    v_lshlrev_b32 v52, 16, v59
    v_and_b32 v53, 0xffff0000, v59
    v_lshlrev_b32 v54, 16, v60
    v_and_b32 v55, 0xffff0000, v60
    ds_write_b64 v5, v[56:57] offset:36864
    ds_write_b64 v5, v[58:59] offset:36880
    ds_write_b32 v6, v60 offset:36864
    ds_write_b64 v5, v[24:25] offset:42240
    ds_write_b64 v5, v[26:27] offset:42256
    ds_write_b32 v6, v28 offset:42240
    s_waitcnt lgkmcnt(0)
    s_mov_b64 exec, 1
    ds_add_u32 v11, v0 offset:2944
    s_mov_b64 exec, -1
    v_mov_b32 v22, v46
    v_mov_b32 v23, v47
    v_mov_b32 v24, v48
    v_mov_b32 v25, v49
    v_mov_b32 v26, v50
    v_mov_b32 v27, v51
    v_mov_b32 v28, v52
    v_mov_b32 v29, v53
    v_mov_b32 v30, v54
    v_mov_b32 v31, v55
    v_mov_b32 v36, 0
    v_mov_b32 v37, 0
    v_mov_b32 v38, 0
    v_mov_b32 v39, 0
    v_mov_b32 v40, 0
    v_mov_b32 v41, 0
    v_mov_b32 v42, 0
    v_mov_b32 v43, 0
    v_mov_b32 v44, 0
    v_mov_b32 v45, 0
    v_lshrrev_b32 v7, 3, v1
    v_lshlrev_b32 v9, 9, v7
    v_and_b32 v7, 7, v1
    v_lshl_add_u32 v9, v7, 4, v9
    v_lshrrev_b32 v7, 5, v1
    v_lshlrev_b32 v10, 9, v7
    v_and_b32 v7, 31, v1
    v_lshl_add_u32 v10, v7, 2, v10
    v_add_u32 v10, 4096, v10
    s_lshl_b32 s8, s3, 7
    s_add_u32 s8, s8, 212992
    s_lshr_b32 s9, s2, 3
    s_add_u32 s4, s9, 0
    s_and_b32 s4, s4, 7
    s_mul_i32 s4, s4, 5120
    s_add_u32 s60, s4, s8
    s_add_u32 s4, s9, 1
    s_and_b32 s4, s4, 7
    s_mul_i32 s4, s4, 5120
    s_add_u32 s61, s4, s8
    s_add_u32 s4, s9, 2
    s_and_b32 s4, s4, 7
    s_mul_i32 s4, s4, 5120
    s_add_u32 s62, s4, s8
    s_add_u32 s4, s9, 3
    s_and_b32 s4, s4, 7
    s_mul_i32 s4, s4, 5120
    s_add_u32 s63, s4, s8
    s_add_u32 s4, s9, 4
    s_and_b32 s4, s4, 7
    s_mul_i32 s4, s4, 5120
    s_add_u32 s64, s4, s8
    s_add_u32 s4, s9, 5
    s_and_b32 s4, s4, 7
    s_mul_i32 s4, s4, 5120
    s_add_u32 s65, s4, s8
    s_add_u32 s4, s9, 6
    s_and_b32 s4, s4, 7
    s_mul_i32 s4, s4, 5120
    s_add_u32 s66, s4, s8
    s_add_u32 s4, s9, 7
    s_and_b32 s4, s4, 7
    s_mul_i32 s4, s4, 5120
    s_add_u32 s67, s4, s8
    s_mov_b32 s10, 0xff
    s_mov_b32 s5, 0
L_x5_loop:
    s_bitcmp1_b32 s10, 0
    s_cbranch_scc0 L_x5l_18
    buffer_load_dwordx4 v[64:67], v9, s[52:55], s60 offen sc1
    buffer_load_dword v68, v10, s[52:55], s60 offen sc1
L_x5l_18:
    s_bitcmp1_b32 s10, 1
    s_cbranch_scc0 L_x5l_19
    buffer_load_dwordx4 v[70:73], v9, s[52:55], s61 offen sc1
    buffer_load_dword v74, v10, s[52:55], s61 offen sc1
L_x5l_19:
    s_bitcmp1_b32 s10, 2
    s_cbranch_scc0 L_x5l_20
    buffer_load_dwordx4 v[76:79], v9, s[52:55], s62 offen sc1
    buffer_load_dword v80, v10, s[52:55], s62 offen sc1
L_x5l_20:
    s_bitcmp1_b32 s10, 3
    s_cbranch_scc0 L_x5l_21
    buffer_load_dwordx4 v[82:85], v9, s[52:55], s63 offen sc1
    buffer_load_dword v86, v10, s[52:55], s63 offen sc1
L_x5l_21:
    s_bitcmp1_b32 s10, 4
    s_cbranch_scc0 L_x5l_22
    buffer_load_dwordx4 v[88:91], v9, s[52:55], s64 offen sc1
    buffer_load_dword v92, v10, s[52:55], s64 offen sc1
L_x5l_22:
    s_bitcmp1_b32 s10, 5
    s_cbranch_scc0 L_x5l_23
    buffer_load_dwordx4 v[94:97], v9, s[52:55], s65 offen sc1
    buffer_load_dword v98, v10, s[52:55], s65 offen sc1
L_x5l_23:
    s_bitcmp1_b32 s10, 6
    s_cbranch_scc0 L_x5l_24
    buffer_load_dwordx4 v[100:103], v9, s[52:55], s66 offen sc1
    buffer_load_dword v104, v10, s[52:55], s66 offen sc1
L_x5l_24:
    s_bitcmp1_b32 s10, 7
    s_cbranch_scc0 L_x5l_25
    buffer_load_dwordx4 v[106:109], v9, s[52:55], s67 offen sc1
    buffer_load_dword v110, v10, s[52:55], s67 offen sc1
L_x5l_25:
    s_add_u32 s5, s5, 1
    s_waitcnt vmcnt(0)
    s_bitcmp1_b32 s10, 0
    s_cbranch_scc0 L_x5c_26
    v_max3_u32 v7, v64, v65, v66
    v_max3_u32 v7, v7, v67, v68
    v_cmp_eq_u32 vcc, -1, v7
    s_nop 3
    s_cbranch_vccnz L_x5c_26
    v_lshlrev_b32 v46, 16, v64
    v_and_b32 v47, 0xffff0000, v64
    v_lshlrev_b32 v48, 16, v65
    v_and_b32 v49, 0xffff0000, v65
    v_lshlrev_b32 v50, 16, v66
    v_and_b32 v51, 0xffff0000, v66
    v_lshlrev_b32 v52, 16, v67
    v_and_b32 v53, 0xffff0000, v67
    v_lshlrev_b32 v54, 16, v68
    v_and_b32 v55, 0xffff0000, v68
    v_pk_add_f32 v[36:37], v[36:37], v[46:47]
    v_pk_add_f32 v[38:39], v[38:39], v[48:49]
    v_pk_add_f32 v[40:41], v[40:41], v[50:51]
    v_pk_add_f32 v[42:43], v[42:43], v[52:53]
    v_pk_add_f32 v[44:45], v[44:45], v[54:55]
    s_bitset0_b32 s10, 0
L_x5c_26:
    s_bitcmp1_b32 s10, 1
    s_cbranch_scc0 L_x5c_27
    v_max3_u32 v7, v70, v71, v72
    v_max3_u32 v7, v7, v73, v74
    v_cmp_eq_u32 vcc, -1, v7
    s_nop 3
    s_cbranch_vccnz L_x5c_27
    v_lshlrev_b32 v46, 16, v70
    v_and_b32 v47, 0xffff0000, v70
    v_lshlrev_b32 v48, 16, v71
    v_and_b32 v49, 0xffff0000, v71
    v_lshlrev_b32 v50, 16, v72
    v_and_b32 v51, 0xffff0000, v72
    v_lshlrev_b32 v52, 16, v73
    v_and_b32 v53, 0xffff0000, v73
    v_lshlrev_b32 v54, 16, v74
    v_and_b32 v55, 0xffff0000, v74
    v_pk_add_f32 v[36:37], v[36:37], v[46:47]
    v_pk_add_f32 v[38:39], v[38:39], v[48:49]
    v_pk_add_f32 v[40:41], v[40:41], v[50:51]
    v_pk_add_f32 v[42:43], v[42:43], v[52:53]
    v_pk_add_f32 v[44:45], v[44:45], v[54:55]
    s_bitset0_b32 s10, 1
L_x5c_27:
    s_bitcmp1_b32 s10, 2
    s_cbranch_scc0 L_x5c_28
    v_max3_u32 v7, v76, v77, v78
    v_max3_u32 v7, v7, v79, v80
    v_cmp_eq_u32 vcc, -1, v7
    s_nop 3
    s_cbranch_vccnz L_x5c_28
    v_lshlrev_b32 v46, 16, v76
    v_and_b32 v47, 0xffff0000, v76
    v_lshlrev_b32 v48, 16, v77
    v_and_b32 v49, 0xffff0000, v77
    v_lshlrev_b32 v50, 16, v78
    v_and_b32 v51, 0xffff0000, v78
    v_lshlrev_b32 v52, 16, v79
    v_and_b32 v53, 0xffff0000, v79
    v_lshlrev_b32 v54, 16, v80
    v_and_b32 v55, 0xffff0000, v80
    v_pk_add_f32 v[36:37], v[36:37], v[46:47]
    v_pk_add_f32 v[38:39], v[38:39], v[48:49]
    v_pk_add_f32 v[40:41], v[40:41], v[50:51]
    v_pk_add_f32 v[42:43], v[42:43], v[52:53]
    v_pk_add_f32 v[44:45], v[44:45], v[54:55]
    s_bitset0_b32 s10, 2
L_x5c_28:
    s_bitcmp1_b32 s10, 3
    s_cbranch_scc0 L_x5c_29
    v_max3_u32 v7, v82, v83, v84
    v_max3_u32 v7, v7, v85, v86
    v_cmp_eq_u32 vcc, -1, v7
    s_nop 3
    s_cbranch_vccnz L_x5c_29
    v_lshlrev_b32 v46, 16, v82
    v_and_b32 v47, 0xffff0000, v82
    v_lshlrev_b32 v48, 16, v83
    v_and_b32 v49, 0xffff0000, v83
    v_lshlrev_b32 v50, 16, v84
    v_and_b32 v51, 0xffff0000, v84
    v_lshlrev_b32 v52, 16, v85
    v_and_b32 v53, 0xffff0000, v85
    v_lshlrev_b32 v54, 16, v86
    v_and_b32 v55, 0xffff0000, v86
    v_pk_add_f32 v[36:37], v[36:37], v[46:47]
    v_pk_add_f32 v[38:39], v[38:39], v[48:49]
    v_pk_add_f32 v[40:41], v[40:41], v[50:51]
    v_pk_add_f32 v[42:43], v[42:43], v[52:53]
    v_pk_add_f32 v[44:45], v[44:45], v[54:55]
    s_bitset0_b32 s10, 3
L_x5c_29:
    s_bitcmp1_b32 s10, 4
    s_cbranch_scc0 L_x5c_30
    v_max3_u32 v7, v88, v89, v90
    v_max3_u32 v7, v7, v91, v92
    v_cmp_eq_u32 vcc, -1, v7
    s_nop 3
    s_cbranch_vccnz L_x5c_30
    v_lshlrev_b32 v46, 16, v88
    v_and_b32 v47, 0xffff0000, v88
    v_lshlrev_b32 v48, 16, v89
    v_and_b32 v49, 0xffff0000, v89
    v_lshlrev_b32 v50, 16, v90
    v_and_b32 v51, 0xffff0000, v90
    v_lshlrev_b32 v52, 16, v91
    v_and_b32 v53, 0xffff0000, v91
    v_lshlrev_b32 v54, 16, v92
    v_and_b32 v55, 0xffff0000, v92
    v_pk_add_f32 v[36:37], v[36:37], v[46:47]
    v_pk_add_f32 v[38:39], v[38:39], v[48:49]
    v_pk_add_f32 v[40:41], v[40:41], v[50:51]
    v_pk_add_f32 v[42:43], v[42:43], v[52:53]
    v_pk_add_f32 v[44:45], v[44:45], v[54:55]
    s_bitset0_b32 s10, 4
L_x5c_30:
    s_bitcmp1_b32 s10, 5
    s_cbranch_scc0 L_x5c_31
    v_max3_u32 v7, v94, v95, v96
    v_max3_u32 v7, v7, v97, v98
    v_cmp_eq_u32 vcc, -1, v7
    s_nop 3
    s_cbranch_vccnz L_x5c_31
    v_lshlrev_b32 v46, 16, v94
    v_and_b32 v47, 0xffff0000, v94
    v_lshlrev_b32 v48, 16, v95
    v_and_b32 v49, 0xffff0000, v95
    v_lshlrev_b32 v50, 16, v96
    v_and_b32 v51, 0xffff0000, v96
    v_lshlrev_b32 v52, 16, v97
    v_and_b32 v53, 0xffff0000, v97
    v_lshlrev_b32 v54, 16, v98
    v_and_b32 v55, 0xffff0000, v98
    v_pk_add_f32 v[36:37], v[36:37], v[46:47]
    v_pk_add_f32 v[38:39], v[38:39], v[48:49]
    v_pk_add_f32 v[40:41], v[40:41], v[50:51]
    v_pk_add_f32 v[42:43], v[42:43], v[52:53]
    v_pk_add_f32 v[44:45], v[44:45], v[54:55]
    s_bitset0_b32 s10, 5
L_x5c_31:
    s_bitcmp1_b32 s10, 6
    s_cbranch_scc0 L_x5c_32
    v_max3_u32 v7, v100, v101, v102
    v_max3_u32 v7, v7, v103, v104
    v_cmp_eq_u32 vcc, -1, v7
    s_nop 3
    s_cbranch_vccnz L_x5c_32
    v_lshlrev_b32 v46, 16, v100
    v_and_b32 v47, 0xffff0000, v100
    v_lshlrev_b32 v48, 16, v101
    v_and_b32 v49, 0xffff0000, v101
    v_lshlrev_b32 v50, 16, v102
    v_and_b32 v51, 0xffff0000, v102
    v_lshlrev_b32 v52, 16, v103
    v_and_b32 v53, 0xffff0000, v103
    v_lshlrev_b32 v54, 16, v104
    v_and_b32 v55, 0xffff0000, v104
    v_pk_add_f32 v[36:37], v[36:37], v[46:47]
    v_pk_add_f32 v[38:39], v[38:39], v[48:49]
    v_pk_add_f32 v[40:41], v[40:41], v[50:51]
    v_pk_add_f32 v[42:43], v[42:43], v[52:53]
    v_pk_add_f32 v[44:45], v[44:45], v[54:55]
    s_bitset0_b32 s10, 6
L_x5c_32:
    s_bitcmp1_b32 s10, 7
    s_cbranch_scc0 L_x5c_33
    v_max3_u32 v7, v106, v107, v108
    v_max3_u32 v7, v7, v109, v110
    v_cmp_eq_u32 vcc, -1, v7
    s_nop 3
    s_cbranch_vccnz L_x5c_33
    v_lshlrev_b32 v46, 16, v106
    v_and_b32 v47, 0xffff0000, v106
    v_lshlrev_b32 v48, 16, v107
    v_and_b32 v49, 0xffff0000, v107
    v_lshlrev_b32 v50, 16, v108
    v_and_b32 v51, 0xffff0000, v108
    v_lshlrev_b32 v52, 16, v109
    v_and_b32 v53, 0xffff0000, v109
    v_lshlrev_b32 v54, 16, v110
    v_and_b32 v55, 0xffff0000, v110
    v_pk_add_f32 v[36:37], v[36:37], v[46:47]
    v_pk_add_f32 v[38:39], v[38:39], v[48:49]
    v_pk_add_f32 v[40:41], v[40:41], v[50:51]
    v_pk_add_f32 v[42:43], v[42:43], v[52:53]
    v_pk_add_f32 v[44:45], v[44:45], v[54:55]
    s_bitset0_b32 s10, 7
L_x5c_33:
    s_cmp_eq_u32 s10, 0
    s_cbranch_scc1 L_x5_done
    s_cmp_lt_u32 s5, 1048576
    s_cbranch_scc1 L_x5_loop
L_x5_done:
    v_pk_fma_f32 v[36:37], v[36:37], v[154:155], v[144:145]
    v_pk_fma_f32 v[38:39], v[38:39], v[156:157], v[146:147]
    v_pk_fma_f32 v[40:41], v[40:41], v[158:159], v[148:149]
    v_pk_fma_f32 v[42:43], v[42:43], v[160:161], v[150:151]
    v_pk_fma_f32 v[44:45], v[44:45], v[162:163], v[152:153]
    v_readfirstlane_b32 s6, v36
    s_nop 1
    v_subrev_f32 v46, s6, v36
    v_subrev_f32 v47, s6, v37
    v_subrev_f32 v48, s6, v38
    v_subrev_f32 v49, s6, v39
    v_subrev_f32 v50, s6, v40
    v_subrev_f32 v51, s6, v41
    v_subrev_f32 v52, s6, v42
    v_subrev_f32 v53, s6, v43
    v_subrev_f32 v54, s6, v44
    v_subrev_f32 v55, s6, v45
    v_pk_mul_f32 v[36:37], v[46:47], v[22:23]
    v_pk_mul_f32 v[38:39], v[48:49], v[24:25]
    v_pk_mul_f32 v[40:41], v[50:51], v[26:27]
    v_pk_mul_f32 v[42:43], v[52:53], v[28:29]
    v_pk_mul_f32 v[44:45], v[54:55], v[30:31]
    v_cvt_pk_bf16_f32 v64, v36, v37
    v_cvt_pk_bf16_f32 v65, v38, v39
    v_cvt_pk_bf16_f32 v66, v40, v41
    v_cvt_pk_bf16_f32 v67, v42, v43
    v_cvt_pk_bf16_f32 v68, v44, v45
    ds_write_b64 v5, v[64:65]
    ds_write_b64 v5, v[66:67] offset:16
    ds_write_b32 v6, v68
    v_pk_add_f32 v[56:57], v[46:47], v[48:49]
    v_pk_mul_f32 v[58:59], v[46:47], v[46:47]
    s_waitcnt lgkmcnt(0)
    s_mov_b64 exec, 1
    ds_add_u32 v11, v0 offset:2916
    s_mov_b64 exec, -1
    v_pk_fma_f32 v[58:59], v[48:49], v[48:49], v[58:59]
    v_pk_add_f32 v[56:57], v[56:57], v[50:51]
    v_pk_fma_f32 v[58:59], v[50:51], v[50:51], v[58:59]
    v_pk_add_f32 v[56:57], v[56:57], v[52:53]
    v_pk_fma_f32 v[58:59], v[52:53], v[52:53], v[58:59]
    v_pk_add_f32 v[56:57], v[56:57], v[54:55]
    v_pk_fma_f32 v[58:59], v[54:55], v[54:55], v[58:59]
    v_add_f32 v56, v56, v57
    v_add_f32 v58, v58, v59
    s_nop 0
    v_add_f32_dpp v56, v56, v56 quad_perm:[1,0,3,2] row_mask:0xf bank_mask:0xf
    v_add_f32_dpp v58, v58, v58 quad_perm:[1,0,3,2] row_mask:0xf bank_mask:0xf
    s_nop 0
    v_add_f32_dpp v56, v56, v56 quad_perm:[2,3,0,1] row_mask:0xf bank_mask:0xf
    v_add_f32_dpp v58, v58, v58 quad_perm:[2,3,0,1] row_mask:0xf bank_mask:0xf
    s_nop 0
    v_add_f32_dpp v56, v56, v56 row_half_mirror row_mask:0xf bank_mask:0xf
    v_add_f32_dpp v58, v58, v58 row_half_mirror row_mask:0xf bank_mask:0xf
    s_nop 0
    v_add_f32_dpp v56, v56, v56 row_mirror row_mask:0xf bank_mask:0xf
    v_add_f32_dpp v58, v58, v58 row_mirror row_mask:0xf bank_mask:0xf
    s_nop 0
    v_add_f32_dpp v56, v56, v56 row_bcast:15 row_mask:0xa bank_mask:0xf
    v_add_f32_dpp v58, v58, v58 row_bcast:15 row_mask:0xa bank_mask:0xf
    s_nop 0
    v_add_f32_dpp v56, v56, v56 row_bcast:31 row_mask:0xc bank_mask:0xf
    v_add_f32_dpp v58, v58, v58 row_bcast:31 row_mask:0xc bank_mask:0xf
    v_readlane_b32 s7, v56, 63
    v_readlane_b32 s9, v58, 63
    v_mov_b32 v62, 0x3acccccd
    v_mul_f32 v60, s7, v62
    v_mul_f32 v62, s9, v62
    v_fma_f32 v62, -v60, v60, v62
    v_add_f32 v60, s6, v60
    v_max_f32 v62, 0, v62
    v_cvt_pk_bf16_f32 v61, v60, v62
    v_and_b32 v62, 0xffff0000, v61
    v_lshlrev_b32 v61, 16, v61
    v_add_f32 v62, 0x3727c5ac, v62
    v_subrev_f32 v61, s6, v61
    v_cvt_pk_bf16_f32 v62, v62, v62
    v_lshlrev_b32 v62, 16, v62
    v_sqrt_f32 v62, v62
    s_nop 0
    v_cvt_pk_bf16_f32 v62, v62, v62
    v_lshlrev_b32 v62, 16, v62
    v_rcp_f32 v60, v62
    s_lshl_b32 s4, s3, 3
    v_add_u32 v7, s4, v11
    s_mov_b64 exec, 1
    ds_write_b64 v7, v[60:61] offset:2976
    ds_add_u32 v11, v0 offset:2948
    s_mov_b64 exec, -1
    s_branch L_A_end
L_A_t6:
    v_lshlrev_b32 v2, 4, v1
    v_lshlrev_b32 v3, 3, v1
    v_bfe_u32 v7, v1, 1, 2
    v_mul_u32_u24 v5, 3136, v7
    v_lshrrev_b32 v7, 4, v1
    v_lshl_add_u32 v5, v7, 6, v5
    v_and_b32 v7, 1, v1
    v_lshl_add_u32 v5, v7, 5, v5
    v_bfe_u32 v7, v1, 3, 1
    v_lshl_add_u32 v5, v7, 3, v5
    v_bfe_u32 v7, v1, 2, 2
    v_mul_u32_u24 v6, 3136, v7
    v_lshrrev_b32 v7, 5, v1
    v_lshl_add_u32 v6, v7, 6, v6
    v_and_b32 v7, 3, v1
    v_lshl_add_u32 v6, v7, 4, v6
    v_bfe_u32 v7, v1, 4, 1
    v_lshl_add_u32 v6, v7, 3, v6
    s_mul_i32 s6, s3, 384
    s_add_u32 s6, s6, 98304
    v_add_u32 v5, s6, v5
    s_add_u32 s6, s6, 256
    v_add_u32 v6, s6, v6
    s_mul_i32 s8, s3, 1536
    s_add_u32 s8, s8, 294912
    s_add_u32 s9, s8, 12288
    s_lshr_b32 s4, s3, 2
    s_lshl_b32 s4, s4, 2
    v_add_u32 v9, s4, v11
    s_mov_b32 s5, 0
Lsp_34:
    ds_read_b32 v7, v11 offset:2960
    s_add_u32 s5, s5, 1
    s_waitcnt lgkmcnt(0)
    v_readfirstlane_b32 s4, v7
    s_nop 0
    s_cmp_ge_u32 s4, 1
    s_nop 1
    s_cbranch_scc1 Lspd_35
    s_sleep 2
    s_cmp_lt_u32 s5, 1048576
    s_cbranch_scc1 Lsp_34
Lspd_35:
    s_mov_b32 s5, 0
Lpl_36:
    buffer_load_dwordx4 v[12:15], v2, s[52:55], s8 offen sc1
    buffer_load_dwordx2 v[16:17], v3, s[52:55], s8 offen offset:1024 sc1
    buffer_load_dwordx4 v[18:21], v2, s[52:55], s9 offen sc1
    buffer_load_dwordx2 v[22:23], v3, s[52:55], s9 offen offset:1024 sc1
    s_add_u32 s5, s5, 1
    s_waitcnt vmcnt(0)
    v_max3_u32 v7, v12, v13, v14
    v_max3_u32 v7, v7, v15, v16
    v_max3_u32 v7, v7, v17, v18
    v_max3_u32 v7, v7, v19, v20
    v_max3_u32 v7, v7, v21, v22
    v_max_u32 v7, v7, v23
    v_cmp_eq_u32 vcc, -1, v7
    s_nop 3
    s_cbranch_vccz Lpld_37
    s_cmp_lt_u32 s5, 1048576
    s_cbranch_scc1 Lpl_36
Lpld_37:
    v_lshlrev_b32 v36, 16, v12
    v_and_b32 v37, 0xffff0000, v12
    v_lshlrev_b32 v38, 16, v13
    v_and_b32 v39, 0xffff0000, v13
    v_lshlrev_b32 v40, 16, v14
    v_and_b32 v41, 0xffff0000, v14
    v_lshlrev_b32 v42, 16, v15
    v_and_b32 v43, 0xffff0000, v15
    v_lshlrev_b32 v44, 16, v16
    v_and_b32 v45, 0xffff0000, v16
    v_lshlrev_b32 v46, 16, v17
    v_and_b32 v47, 0xffff0000, v17
    v_lshlrev_b32 v48, 16, v18
    v_and_b32 v49, 0xffff0000, v18
    v_lshlrev_b32 v50, 16, v19
    v_and_b32 v51, 0xffff0000, v19
    v_lshlrev_b32 v52, 16, v20
    v_and_b32 v53, 0xffff0000, v20
    v_lshlrev_b32 v54, 16, v21
    v_and_b32 v55, 0xffff0000, v21
    v_lshlrev_b32 v56, 16, v22
    v_and_b32 v57, 0xffff0000, v22
    v_lshlrev_b32 v58, 16, v23
    v_and_b32 v59, 0xffff0000, v23
    v_max_f32 v36, 0, v36
    v_max_f32 v37, 0, v37
    v_max_f32 v38, 0, v38
    v_max_f32 v39, 0, v39
    v_max_f32 v40, 0, v40
    v_max_f32 v41, 0, v41
    v_max_f32 v42, 0, v42
    v_max_f32 v43, 0, v43
    v_max_f32 v44, 0, v44
    v_max_f32 v45, 0, v45
    v_max_f32 v46, 0, v46
    v_max_f32 v47, 0, v47
    v_pk_mul_f32 v[36:37], v[36:37], v[48:49]
    v_pk_mul_f32 v[38:39], v[38:39], v[50:51]
    v_pk_mul_f32 v[40:41], v[40:41], v[52:53]
    v_pk_mul_f32 v[42:43], v[42:43], v[54:55]
    v_pk_mul_f32 v[44:45], v[44:45], v[56:57]
    v_pk_mul_f32 v[46:47], v[46:47], v[58:59]
    v_cvt_pk_bf16_f32 v12, v36, v37
    v_cvt_pk_bf16_f32 v13, v38, v39
    v_cvt_pk_bf16_f32 v14, v40, v41
    v_cvt_pk_bf16_f32 v15, v42, v43
    v_cvt_pk_bf16_f32 v16, v44, v45
    v_cvt_pk_bf16_f32 v17, v46, v47
    ds_write_b64 v5, v[12:13]
    ds_write_b64 v5, v[14:15] offset:16
    ds_write_b64 v6, v[16:17]
    s_waitcnt lgkmcnt(0)
    s_mov_b64 exec, 1
    ds_add_u32 v9, v0 offset:2952
    s_mov_b64 exec, -1
L_A_end:
    s_endpgm
L_D:
    s_setprio 3
    s_sub_u32 s3, s3, 8
    v_mov_b32 v2, 110592
    v_mov_b32 v0, 1
    s_waitcnt lgkmcnt(0)
    s_mov_b32 s52, s42
    s_mov_b32 s53, s43
    s_mov_b32 s54, 2097152
    s_mov_b32 s55, 0x00020000
    s_mov_b32 s64, s40
    s_mov_b32 s65, s41
    s_mov_b32 s66, 256
    s_mov_b32 s67, 0x00020000
    s_cmp_lg_u32 s3, 1
    s_cbranch_scc1 L_D_noclr
    s_cmp_lt_u32 s2, 236
    s_cbranch_scc1 L_D_noclr
    v_mov_b32 v16, -1
    v_mov_b32 v17, -1
    v_mov_b32 v18, -1
    v_mov_b32 v19, -1
    v_lshlrev_b32 v8, 4, v1
    s_sub_u32 s4, s2, 236
    s_mul_i32 s5, s4, 23552
    buffer_store_dwordx4 v[16:19], v8, s[52:55], s5 offen offset:0 sc1
    buffer_store_dwordx4 v[16:19], v8, s[52:55], s5 offen offset:1024 sc1
    buffer_store_dwordx4 v[16:19], v8, s[52:55], s5 offen offset:2048 sc1
    buffer_store_dwordx4 v[16:19], v8, s[52:55], s5 offen offset:3072 sc1
    s_add_u32 s5, s5, 4096
    buffer_store_dwordx4 v[16:19], v8, s[52:55], s5 offen offset:0 sc1
    buffer_store_dwordx4 v[16:19], v8, s[52:55], s5 offen offset:1024 sc1
    buffer_store_dwordx4 v[16:19], v8, s[52:55], s5 offen offset:2048 sc1
    buffer_store_dwordx4 v[16:19], v8, s[52:55], s5 offen offset:3072 sc1
    s_add_u32 s5, s5, 4096
    buffer_store_dwordx4 v[16:19], v8, s[52:55], s5 offen offset:0 sc1
    buffer_store_dwordx4 v[16:19], v8, s[52:55], s5 offen offset:1024 sc1
    buffer_store_dwordx4 v[16:19], v8, s[52:55], s5 offen offset:2048 sc1
    buffer_store_dwordx4 v[16:19], v8, s[52:55], s5 offen offset:3072 sc1
    s_add_u32 s5, s5, 4096
    buffer_store_dwordx4 v[16:19], v8, s[52:55], s5 offen offset:0 sc1
    buffer_store_dwordx4 v[16:19], v8, s[52:55], s5 offen offset:1024 sc1
    buffer_store_dwordx4 v[16:19], v8, s[52:55], s5 offen offset:2048 sc1
    buffer_store_dwordx4 v[16:19], v8, s[52:55], s5 offen offset:3072 sc1
    s_add_u32 s5, s5, 4096
    buffer_store_dwordx4 v[16:19], v8, s[52:55], s5 offen offset:0 sc1
    buffer_store_dwordx4 v[16:19], v8, s[52:55], s5 offen offset:1024 sc1
    buffer_store_dwordx4 v[16:19], v8, s[52:55], s5 offen offset:2048 sc1
    buffer_store_dwordx4 v[16:19], v8, s[52:55], s5 offen offset:3072 sc1
    s_add_u32 s5, s5, 4096
    buffer_store_dwordx4 v[16:19], v8, s[52:55], s5 offen offset:0 sc1
    buffer_store_dwordx4 v[16:19], v8, s[52:55], s5 offen offset:1024 sc1
    buffer_store_dwordx4 v[16:19], v8, s[52:55], s5 offen offset:2048 sc1
    v_mov_b32 v9, 0
    v_mov_b32 v10, 1
    s_waitcnt vmcnt(0)
    s_mov_b64 exec, 1
    buffer_atomic_add v10, v9, s[64:67], 0 offen sc0 sc1
    s_waitcnt vmcnt(0)
    v_readfirstlane_b32 s4, v10
    s_nop 0
    s_cmp_lg_u32 s4, 19
    s_nop 1
    s_cbranch_scc1 L_D_clr2
    buffer_store_dword v0, v9, s[64:67], 0 offen offset:128 sc1
L_D_clr2:
    ds_add_u32 v2, v0 offset:2932
    s_mov_b64 exec, -1
L_D_noclr:
    v_and_b32 v8, 3, v1
    v_mul_u32_u24 v5, 1344, v8
    v_lshrrev_b32 v9, 4, v1
    v_lshl_add_u32 v5, v9, 4, v5
    v_add_u32 v5, 98304, v5
    v_lshrrev_b32 v10, 2, v1
    v_lshlrev_b32 v3, 7, v10
    v_bfe_u32 v10, v1, 3, 2
    v_xor_b32 v10, s3, v10
    v_lshl_add_u32 v3, v10, 5, v3
    v_and_b32 v10, 3, v1
    v_lshl_add_u32 v3, v10, 3, v3
    v_add_u32 v4, 40960, v3
    s_cmp_lt_u32 s2, 156
    s_cbranch_scc1 L_D_A
    s_cmp_lg_u32 s3, 3
    s_cbranch_scc1 L_D_noflag_38
    v_mov_b32 v8, 128
    s_mov_b32 s5, 0
L_D_flag_39:
    buffer_load_dword v9, v8, s[64:67], 0 offen sc1
    s_add_u32 s5, s5, 1
    s_waitcnt vmcnt(0)
    v_cmp_eq_u32 vcc, 0, v9
    s_nop 3
    s_cbranch_vccz L_D_flagd_40
    s_sleep 2
    s_cmp_lt_u32 s5, 1048576
    s_cbranch_scc1 L_D_flag_39
L_D_flagd_40:
    s_mov_b64 exec, 1
    ds_add_u32 v2, v0 offset:2920
    s_mov_b64 exec, -1
L_D_noflag_38:
    s_branch L_D_noA
L_D_A:
    v_lshlrev_b32 v76, 3, v1
    v_lshlrev_b32 v77, 2, v1
    v_lshrrev_b32 v8, 3, v1
    v_lshlrev_b32 v78, 6, v8
    v_and_b32 v8, 3, v1
    v_lshl_add_u32 v78, v8, 4, v78
    v_bfe_u32 v8, v1, 2, 1
    v_lshl_add_u32 v78, v8, 3, v78
    v_lshrrev_b32 v9, 1, v1
    v_lshrrev_b32 v8, 3, v9
    v_lshlrev_b32 v79, 6, v8
    v_and_b32 v8, 3, v9
    v_lshl_add_u32 v79, v8, 4, v79
    v_bfe_u32 v8, v9, 2, 1
    v_lshl_add_u32 v79, v8, 3, v79
    v_and_b32 v8, 1, v1
    v_lshl_add_u32 v79, v8, 2, v79
    v_add_u32 v79, 1024, v79
    s_mul_i32 s6, s3, 1344
    s_add_u32 s6, s6, 98304
    v_add_u32 v78, s6, v78
    v_add_u32 v79, s6, v79
    s_cmp_lt_u32 s2, 60
    s_cselect_b32 s60, s34, s16
    s_cselect_b32 s61, s35, s17
    s_mov_b32 s62, 5120
    s_mov_b32 s63, 0x00020000
    s_mul_i32 s8, s3, 1280
    buffer_load_dwordx2 v[16:17], v76, s[60:63], s8 offen
    buffer_load_dwordx2 v[18:19], v76, s[60:63], s8 offen offset:512
    buffer_load_dword v20, v77, s[60:63], s8 offen offset:1024
    s_waitcnt vmcnt(0)
    v_lshlrev_b32 v36, 16, v16
    v_and_b32 v37, 0xffff0000, v16
    v_lshlrev_b32 v38, 16, v17
    v_and_b32 v39, 0xffff0000, v17
    v_lshlrev_b32 v40, 16, v18
    v_and_b32 v41, 0xffff0000, v18
    v_lshlrev_b32 v42, 16, v19
    v_and_b32 v43, 0xffff0000, v19
    v_lshlrev_b32 v44, 16, v20
    v_and_b32 v45, 0xffff0000, v20
    s_cmp_ge_u32 s2, 60
    s_cbranch_scc1 L_D_A2
    v_mov_b32 v80, 0x200
    v_mul_f32 v46, 0xbfb8aa3b, v36
    v_mul_f32 v47, 0xbfb8aa3b, v37
    v_mul_f32 v48, 0xbfb8aa3b, v38
    v_mul_f32 v49, 0xbfb8aa3b, v39
    v_mul_f32 v50, 0xbfb8aa3b, v40
    v_mul_f32 v51, 0xbfb8aa3b, v41
    v_mul_f32 v52, 0xbfb8aa3b, v42
    v_mul_f32 v53, 0xbfb8aa3b, v43
    v_mul_f32 v54, 0xbfb8aa3b, v44
    v_mul_f32 v55, 0xbfb8aa3b, v45
    v_exp_f32 v46, v46
    v_exp_f32 v47, v47
    v_exp_f32 v48, v48
    v_exp_f32 v49, v49
    v_exp_f32 v50, v50
    v_exp_f32 v51, v51
    v_exp_f32 v52, v52
    v_exp_f32 v53, v53
    v_exp_f32 v54, v54
    v_exp_f32 v55, v55
    v_add_f32 v46, 1.0, v46
    v_add_f32 v47, 1.0, v47
    v_add_f32 v48, 1.0, v48
    v_add_f32 v49, 1.0, v49
    v_add_f32 v50, 1.0, v50
    v_add_f32 v51, 1.0, v51
    v_add_f32 v52, 1.0, v52
    v_add_f32 v53, 1.0, v53
    v_add_f32 v54, 1.0, v54
    v_add_f32 v55, 1.0, v55
    v_rcp_f32 v56, v46
    v_rcp_f32 v57, v47
    v_rcp_f32 v58, v48
    v_rcp_f32 v59, v49
    v_rcp_f32 v60, v50
    v_rcp_f32 v61, v51
    v_rcp_f32 v62, v52
    v_rcp_f32 v63, v53
    v_rcp_f32 v64, v54
    v_rcp_f32 v65, v55
    v_mul_f32 v66, v36, v56
    v_mul_f32 v67, v37, v57
    v_mul_f32 v68, v38, v58
    v_mul_f32 v69, v39, v59
    v_mul_f32 v70, v40, v60
    v_mul_f32 v71, v41, v61
    v_mul_f32 v72, v42, v62
    v_mul_f32 v73, v43, v63
    v_mul_f32 v74, v44, v64
    v_mul_f32 v75, v45, v65
    v_fma_f32 v36, -v66, v46, v36
    v_fma_f32 v37, -v67, v47, v37
    v_fma_f32 v38, -v68, v48, v38
    v_fma_f32 v39, -v69, v49, v39
    v_fma_f32 v40, -v70, v50, v40
    v_fma_f32 v41, -v71, v51, v41
    v_fma_f32 v42, -v72, v52, v42
    v_fma_f32 v43, -v73, v53, v43
    v_fma_f32 v44, -v74, v54, v44
    v_fma_f32 v45, -v75, v55, v45
    v_fma_f32 v36, v36, v56, v66
    v_fma_f32 v37, v37, v57, v67
    v_fma_f32 v38, v38, v58, v68
    v_fma_f32 v39, v39, v59, v69
    v_fma_f32 v40, v40, v60, v70
    v_fma_f32 v41, v41, v61, v71
    v_fma_f32 v42, v42, v62, v72
    v_fma_f32 v43, v43, v63, v73
    v_fma_f32 v44, v44, v64, v74
    v_fma_f32 v45, v45, v65, v75
    v_cmp_class_f32 vcc, v46, v80
    s_nop 1
    v_cndmask_b32 v36, v36, v66, vcc
    v_cmp_class_f32 vcc, v47, v80
    s_nop 1
    v_cndmask_b32 v37, v37, v67, vcc
    v_cmp_class_f32 vcc, v48, v80
    s_nop 1
    v_cndmask_b32 v38, v38, v68, vcc
    v_cmp_class_f32 vcc, v49, v80
    s_nop 1
    v_cndmask_b32 v39, v39, v69, vcc
    v_cmp_class_f32 vcc, v50, v80
    s_nop 1
    v_cndmask_b32 v40, v40, v70, vcc
    v_cmp_class_f32 vcc, v51, v80
    s_nop 1
    v_cndmask_b32 v41, v41, v71, vcc
    v_cmp_class_f32 vcc, v52, v80
    s_nop 1
    v_cndmask_b32 v42, v42, v72, vcc
    v_cmp_class_f32 vcc, v53, v80
    s_nop 1
    v_cndmask_b32 v43, v43, v73, vcc
    v_cmp_class_f32 vcc, v54, v80
    s_nop 1
    v_cndmask_b32 v44, v44, v74, vcc
    v_cmp_class_f32 vcc, v55, v80
    s_nop 1
    v_cndmask_b32 v45, v45, v75, vcc
    v_cvt_pk_bf16_f32 v16, v36, v37
    v_cvt_pk_bf16_f32 v17, v38, v39
    v_cvt_pk_bf16_f32 v18, v40, v41
    v_cvt_pk_bf16_f32 v19, v42, v43
    v_cvt_pk_bf16_f32 v20, v44, v45
    ds_write_b64 v78, v[16:17]
    ds_write_b64 v78, v[18:19] offset:512
    ds_write_b32 v79, v20
    s_waitcnt lgkmcnt(0)
    s_mov_b64 exec, 1
    ds_add_u32 v2, v0 offset:2904
    s_mov_b64 exec, -1
    s_branch L_D_A3
L_D_A2:
    v_add_f32 v46, v36, v37
    v_add_f32 v46, v46, v38
    v_add_f32 v46, v46, v39
    v_add_f32 v46, v46, v40
    v_add_f32 v46, v46, v41
    v_add_f32 v46, v46, v42
    v_add_f32 v46, v46, v43
    v_add_f32 v46, v46, v44
    v_add_f32 v46, v46, v45
    s_nop 1
    v_add_f32_dpp v46, v46, v46 quad_perm:[1,0,3,2] row_mask:0xf bank_mask:0xf
    s_nop 1
    v_add_f32_dpp v46, v46, v46 quad_perm:[2,3,0,1] row_mask:0xf bank_mask:0xf
    s_nop 1
    v_add_f32_dpp v46, v46, v46 row_half_mirror row_mask:0xf bank_mask:0xf
    s_nop 1
    v_add_f32_dpp v46, v46, v46 row_mirror row_mask:0xf bank_mask:0xf
    s_nop 1
    v_add_f32_dpp v46, v46, v46 row_bcast:15 row_mask:0xa bank_mask:0xf
    s_nop 1
    v_add_f32_dpp v46, v46, v46 row_bcast:31 row_mask:0xc bank_mask:0xf
    s_nop 0
    v_readlane_b32 s6, v46, 63
    v_mov_b32 v56, 0x3acccccd
    s_nop 0
    v_mul_f32 v56, s6, v56
    v_sub_f32 v46, v36, v56
    v_sub_f32 v47, v37, v56
    v_sub_f32 v48, v38, v56
    v_sub_f32 v49, v39, v56
    v_sub_f32 v50, v40, v56
    v_sub_f32 v51, v41, v56
    v_sub_f32 v52, v42, v56
    v_sub_f32 v53, v43, v56
    v_sub_f32 v54, v44, v56
    v_sub_f32 v55, v45, v56
    v_mul_f32 v57, v46, v46
    v_fmac_f32 v57, v47, v47
    v_fmac_f32 v57, v48, v48
    v_fmac_f32 v57, v49, v49
    v_fmac_f32 v57, v50, v50
    v_fmac_f32 v57, v51, v51
    v_fmac_f32 v57, v52, v52
    v_fmac_f32 v57, v53, v53
    v_fmac_f32 v57, v54, v54
    v_fmac_f32 v57, v55, v55
    s_nop 1
    v_add_f32_dpp v57, v57, v57 quad_perm:[1,0,3,2] row_mask:0xf bank_mask:0xf
    s_nop 1
    v_add_f32_dpp v57, v57, v57 quad_perm:[2,3,0,1] row_mask:0xf bank_mask:0xf
    s_nop 1
    v_add_f32_dpp v57, v57, v57 row_half_mirror row_mask:0xf bank_mask:0xf
    s_nop 1
    v_add_f32_dpp v57, v57, v57 row_mirror row_mask:0xf bank_mask:0xf
    s_nop 1
    v_add_f32_dpp v57, v57, v57 row_bcast:15 row_mask:0xa bank_mask:0xf
    s_nop 1
    v_add_f32_dpp v57, v57, v57 row_bcast:31 row_mask:0xc bank_mask:0xf
    s_nop 0
    v_readlane_b32 s7, v57, 63
    v_mov_b32 v57, 0x3acccccd
    s_nop 0
    v_mul_f32 v57, s7, v57
    v_cvt_pk_bf16_f32 v57, v57, v57
    v_lshlrev_b32 v57, 16, v57
    v_add_f32 v57, 0x3727c5ac, v57
    v_cvt_pk_bf16_f32 v57, v57, v57
    v_lshlrev_b32 v57, 16, v57
    v_sqrt_f32 v57, v57
    s_nop 0
    v_cvt_pk_bf16_f32 v57, v57, v57
    v_lshlrev_b32 v57, 16, v57
    v_rcp_f32 v58, v57
    v_cvt_pk_bf16_f32 v56, v56, v56
    v_lshlrev_b32 v56, 16, v56
    v_sub_f32 v36, v36, v56
    v_sub_f32 v37, v37, v56
    v_sub_f32 v38, v38, v56
    v_sub_f32 v39, v39, v56
    v_sub_f32 v40, v40, v56
    v_sub_f32 v41, v41, v56
    v_sub_f32 v42, v42, v56
    v_sub_f32 v43, v43, v56
    v_sub_f32 v44, v44, v56
    v_sub_f32 v45, v45, v56
    v_cvt_pk_bf16_f32 v46, v36, v37
    v_cvt_pk_bf16_f32 v47, v38, v39
    v_cvt_pk_bf16_f32 v48, v40, v41
    v_cvt_pk_bf16_f32 v49, v42, v43
    v_cvt_pk_bf16_f32 v50, v44, v45
    v_lshlrev_b32 v36, 16, v46
    v_and_b32 v37, 0xffff0000, v46
    v_lshlrev_b32 v38, 16, v47
    v_and_b32 v39, 0xffff0000, v47
    v_lshlrev_b32 v40, 16, v48
    v_and_b32 v41, 0xffff0000, v48
    v_lshlrev_b32 v42, 16, v49
    v_and_b32 v43, 0xffff0000, v49
    v_lshlrev_b32 v44, 16, v50
    v_and_b32 v45, 0xffff0000, v50
    v_mul_f32 v46, v36, v58
    v_mul_f32 v47, v37, v58
    v_mul_f32 v48, v38, v58
    v_mul_f32 v49, v39, v58
    v_mul_f32 v50, v40, v58
    v_mul_f32 v51, v41, v58
    v_mul_f32 v52, v42, v58
    v_mul_f32 v53, v43, v58
    v_mul_f32 v54, v44, v58
    v_mul_f32 v55, v45, v58
    v_fma_f32 v36, -v46, v57, v36
    v_fma_f32 v37, -v47, v57, v37
    v_fma_f32 v38, -v48, v57, v38
    v_fma_f32 v39, -v49, v57, v39
    v_fma_f32 v40, -v50, v57, v40
    v_fma_f32 v41, -v51, v57, v41
    v_fma_f32 v42, -v52, v57, v42
    v_fma_f32 v43, -v53, v57, v43
    v_fma_f32 v44, -v54, v57, v44
    v_fma_f32 v45, -v55, v57, v45
    v_fma_f32 v36, v36, v58, v46
    v_fma_f32 v37, v37, v58, v47
    v_fma_f32 v38, v38, v58, v48
    v_fma_f32 v39, v39, v58, v49
    v_fma_f32 v40, v40, v58, v50
    v_fma_f32 v41, v41, v58, v51
    v_fma_f32 v42, v42, v58, v52
    v_fma_f32 v43, v43, v58, v53
    v_fma_f32 v44, v44, v58, v54
    v_fma_f32 v45, v45, v58, v55
    v_cvt_pk_bf16_f32 v46, v36, v37
    v_cvt_pk_bf16_f32 v47, v38, v39
    v_cvt_pk_bf16_f32 v48, v40, v41
    v_cvt_pk_bf16_f32 v49, v42, v43
    v_cvt_pk_bf16_f32 v50, v44, v45
    v_lshlrev_b32 v36, 16, v46
    v_and_b32 v37, 0xffff0000, v46
    v_lshlrev_b32 v38, 16, v47
    v_and_b32 v39, 0xffff0000, v47
    v_lshlrev_b32 v40, 16, v48
    v_and_b32 v41, 0xffff0000, v48
    v_lshlrev_b32 v42, 16, v49
    v_and_b32 v43, 0xffff0000, v49
    v_lshlrev_b32 v44, 16, v50
    v_and_b32 v45, 0xffff0000, v50
    v_cvt_pk_bf16_f32 v16, v36, v37
    v_cvt_pk_bf16_f32 v17, v38, v39
    v_cvt_pk_bf16_f32 v18, v40, v41
    v_cvt_pk_bf16_f32 v19, v42, v43
    v_cvt_pk_bf16_f32 v20, v44, v45
    ds_write_b64 v78, v[16:17]
    ds_write_b64 v78, v[18:19] offset:512
    ds_write_b32 v79, v20
    s_waitcnt lgkmcnt(0)
    s_mov_b64 exec, 1
    ds_add_u32 v2, v0 offset:2936
    s_mov_b64 exec, -1
    v_bfe_u32 v8, v1, 1, 2
    v_mul_u32_u24 v78, 1344, v8
    v_lshrrev_b32 v8, 4, v1
    v_lshl_add_u32 v78, v8, 6, v78
    v_and_b32 v8, 1, v1
    v_lshl_add_u32 v78, v8, 5, v78
    v_bfe_u32 v8, v1, 3, 1
    v_lshl_add_u32 v78, v8, 3, v78
    v_bfe_u32 v8, v1, 3, 2
    v_mul_u32_u24 v79, 1344, v8
    v_bfe_u32 v8, v1, 1, 2
    v_lshl_add_u32 v79, v8, 4, v79
    v_lshrrev_b32 v8, 5, v1
    v_lshl_add_u32 v79, v8, 3, v79
    v_and_b32 v8, 1, v1
    v_lshl_add_u32 v79, v8, 2, v79
    s_mul_i32 s6, s3, 320
    s_add_u32 s6, s6, 98304
    v_add_u32 v78, s6, v78
    s_add_u32 s6, s6, 256
    v_add_u32 v79, s6, v79
    v_lshlrev_b32 v76, 4, v1
L_D_A3:
    s_cmp_lg_u32 s3, 3
    s_cbranch_scc1 L_D_noflag_41
    v_mov_b32 v8, 128
    s_mov_b32 s5, 0
L_D_flag_42:
    buffer_load_dword v9, v8, s[64:67], 0 offen sc1
    s_add_u32 s5, s5, 1
    s_waitcnt vmcnt(0)
    v_cmp_eq_u32 vcc, 0, v9
    s_nop 3
    s_cbranch_vccz L_D_flagd_43
    s_sleep 2
    s_cmp_lt_u32 s5, 1048576
    s_cbranch_scc1 L_D_flag_42
L_D_flagd_43:
    s_mov_b64 exec, 1
    ds_add_u32 v2, v0 offset:2920
    s_mov_b64 exec, -1
L_D_noflag_41:
    s_mov_b32 s5, 0
Lsp_44:
    ds_read_b32 v8, v2 offset:2880
    s_add_u32 s5, s5, 1
    s_waitcnt lgkmcnt(0)
    v_readfirstlane_b32 s4, v8
    s_nop 0
    s_cmp_ge_u32 s4, 8
    s_nop 1
    s_cbranch_scc1 Lspd_45
    s_sleep 1
    s_cmp_lt_u32 s5, 1048576
    s_cbranch_scc1 Lsp_44
Lspd_45:
    ds_read_b64_tr_b16 v[88:89], v3 offset:0
    ds_read_b64_tr_b16 v[90:91], v3 offset:2048
    ds_read_b64_tr_b16 v[92:93], v3 offset:4096
    ds_read_b64_tr_b16 v[94:95], v3 offset:6144
    ds_read_b64_tr_b16 v[96:97], v3 offset:8192
    ds_read_b64_tr_b16 v[98:99], v3 offset:10240
    ds_read_b64_tr_b16 v[100:101], v3 offset:12288
    ds_read_b64_tr_b16 v[102:103], v3 offset:14336
    ds_read_b64_tr_b16 v[104:105], v3 offset:16384
    ds_read_b64_tr_b16 v[106:107], v3 offset:18432
    ds_read_b64_tr_b16 v[108:109], v3 offset:20480
    ds_read_b64_tr_b16 v[110:111], v3 offset:22528
    ds_read_b64_tr_b16 v[112:113], v3 offset:24576
    ds_read_b64_tr_b16 v[114:115], v3 offset:26624
    ds_read_b64_tr_b16 v[116:117], v3 offset:28672
    ds_read_b64_tr_b16 v[118:119], v3 offset:30720
    ds_read_b64_tr_b16 v[120:121], v3 offset:32768
    ds_read_b64_tr_b16 v[122:123], v3 offset:34816
    ds_read_b64_tr_b16 v[124:125], v3 offset:36864
    ds_read_b64_tr_b16 v[126:127], v3 offset:38912
    ds_read_b64_tr_b16 v[128:129], v4 offset:0
    ds_read_b64_tr_b16 v[130:131], v4 offset:2048
    ds_read_b64_tr_b16 v[132:133], v4 offset:4096
    ds_read_b64_tr_b16 v[134:135], v4 offset:6144
    ds_read_b64_tr_b16 v[136:137], v4 offset:8192
    ds_read_b64_tr_b16 v[138:139], v4 offset:10240
    ds_read_b64_tr_b16 v[140:141], v4 offset:12288
    ds_read_b64_tr_b16 v[142:143], v4 offset:14336
    ds_read_b64_tr_b16 v[144:145], v4 offset:16384
    ds_read_b64_tr_b16 v[146:147], v4 offset:18432
    ds_read_b64_tr_b16 v[148:149], v4 offset:20480
    ds_read_b64_tr_b16 v[150:151], v4 offset:22528
    ds_read_b64_tr_b16 v[152:153], v4 offset:24576
    ds_read_b64_tr_b16 v[154:155], v4 offset:26624
    ds_read_b64_tr_b16 v[156:157], v4 offset:28672
    ds_read_b64_tr_b16 v[158:159], v4 offset:30720
    ds_read_b64_tr_b16 v[160:161], v4 offset:32768
    ds_read_b64_tr_b16 v[162:163], v4 offset:34816
    ds_read_b64_tr_b16 v[164:165], v4 offset:36864
    ds_read_b64_tr_b16 v[166:167], v4 offset:38912
    s_waitcnt lgkmcnt(0)
    s_mov_b64 exec, 1
    ds_add_u32 v2, v0 offset:2908
    s_mov_b64 exec, -1
    s_mov_b32 s5, 0
Lsp_46:
    ds_read_b32 v8, v2 offset:2920
    s_add_u32 s5, s5, 1
    s_waitcnt lgkmcnt(0)
    v_readfirstlane_b32 s4, v8
    s_nop 0
    s_cmp_ge_u32 s4, 1
    s_nop 1
    s_cbranch_scc1 Lspd_47
    s_sleep 1
    s_cmp_lt_u32 s5, 1048576
    s_cbranch_scc1 Lsp_46
Lspd_47:
    s_cmp_lt_u32 s2, 60
    s_cbranch_scc1 L_D_A4
    s_mov_b32 s5, 0
Lsp_48:
    ds_read_b32 v8, v2 offset:2936
    s_add_u32 s5, s5, 1
    s_waitcnt lgkmcnt(0)
    v_readfirstlane_b32 s4, v8
    s_nop 0
    s_cmp_ge_u32 s4, 4
    s_nop 1
    s_cbranch_scc1 Lspd_49
    s_sleep 1
    s_cmp_lt_u32 s5, 1048576
    s_cbranch_scc1 Lsp_48
Lspd_49:
    ds_read_b64 v[16:17], v78
    ds_read_b64 v[18:19], v78 offset:16
    ds_read_b32 v20, v79
    s_mul_i32 s8, s3, 1280
    s_add_u32 s8, s8, 0
    s_add_u32 s9, s8, 5120
    s_waitcnt lgkmcnt(0)
    v_lshlrev_b32 v36, 16, v16
    v_and_b32 v37, 0xffff0000, v16
    v_lshlrev_b32 v38, 16, v17
    v_and_b32 v39, 0xffff0000, v17
    v_lshlrev_b32 v40, 16, v18
    v_and_b32 v41, 0xffff0000, v18
    v_lshlrev_b32 v42, 16, v19
    v_and_b32 v43, 0xffff0000, v19
    v_lshlrev_b32 v44, 16, v20
    v_and_b32 v45, 0xffff0000, v20
    s_mov_b32 s5, 0
Lpl_50:
    buffer_load_dwordx4 v[22:25], v76, s[52:55], s8 offen sc1
    buffer_load_dword v26, v77, s[52:55], s8 offen offset:1024 sc1
    buffer_load_dwordx4 v[28:31], v76, s[52:55], s9 offen sc1
    buffer_load_dword v32, v77, s[52:55], s9 offen offset:1024 sc1
    s_add_u32 s5, s5, 1
    s_waitcnt vmcnt(0)
    v_max3_u32 v8, v22, v23, v24
    v_max3_u32 v8, v8, v25, v26
    v_max3_u32 v8, v8, v28, v29
    v_max3_u32 v8, v8, v30, v31
    v_max_u32 v8, v8, v32
    v_cmp_eq_u32 vcc, -1, v8
    s_nop 3
    s_cbranch_vccz Lpld_51
    s_sleep 1
    s_cmp_lt_u32 s5, 1048576
    s_cbranch_scc1 Lpl_50
Lpld_51:
    v_lshlrev_b32 v46, 16, v28
    v_and_b32 v47, 0xffff0000, v28
    v_lshlrev_b32 v48, 16, v29
    v_and_b32 v49, 0xffff0000, v29
    v_lshlrev_b32 v50, 16, v30
    v_and_b32 v51, 0xffff0000, v30
    v_lshlrev_b32 v52, 16, v31
    v_and_b32 v53, 0xffff0000, v31
    v_lshlrev_b32 v54, 16, v32
    v_and_b32 v55, 0xffff0000, v32
    v_add_f32 v46, 1.0, v46
    v_add_f32 v47, 1.0, v47
    v_add_f32 v48, 1.0, v48
    v_add_f32 v49, 1.0, v49
    v_add_f32 v50, 1.0, v50
    v_add_f32 v51, 1.0, v51
    v_add_f32 v52, 1.0, v52
    v_add_f32 v53, 1.0, v53
    v_add_f32 v54, 1.0, v54
    v_add_f32 v55, 1.0, v55
    v_cvt_pk_bf16_f32 v56, v46, v47
    v_cvt_pk_bf16_f32 v57, v48, v49
    v_cvt_pk_bf16_f32 v58, v50, v51
    v_cvt_pk_bf16_f32 v59, v52, v53
    v_cvt_pk_bf16_f32 v60, v54, v55
    v_lshlrev_b32 v46, 16, v56
    v_and_b32 v47, 0xffff0000, v56
    v_lshlrev_b32 v48, 16, v57
    v_and_b32 v49, 0xffff0000, v57
    v_lshlrev_b32 v50, 16, v58
    v_and_b32 v51, 0xffff0000, v58
    v_lshlrev_b32 v52, 16, v59
    v_and_b32 v53, 0xffff0000, v59
    v_lshlrev_b32 v54, 16, v60
    v_and_b32 v55, 0xffff0000, v60
    v_mul_f32 v36, v36, v46
    v_mul_f32 v37, v37, v47
    v_mul_f32 v38, v38, v48
    v_mul_f32 v39, v39, v49
    v_mul_f32 v40, v40, v50
    v_mul_f32 v41, v41, v51
    v_mul_f32 v42, v42, v52
    v_mul_f32 v43, v43, v53
    v_mul_f32 v44, v44, v54
    v_mul_f32 v45, v45, v55
    v_cvt_pk_bf16_f32 v56, v36, v37
    v_cvt_pk_bf16_f32 v57, v38, v39
    v_cvt_pk_bf16_f32 v58, v40, v41
    v_cvt_pk_bf16_f32 v59, v42, v43
    v_cvt_pk_bf16_f32 v60, v44, v45
    v_lshlrev_b32 v36, 16, v56
    v_and_b32 v37, 0xffff0000, v56
    v_lshlrev_b32 v38, 16, v57
    v_and_b32 v39, 0xffff0000, v57
    v_lshlrev_b32 v40, 16, v58
    v_and_b32 v41, 0xffff0000, v58
    v_lshlrev_b32 v42, 16, v59
    v_and_b32 v43, 0xffff0000, v59
    v_lshlrev_b32 v44, 16, v60
    v_and_b32 v45, 0xffff0000, v60
    v_lshlrev_b32 v46, 16, v22
    v_and_b32 v47, 0xffff0000, v22
    v_lshlrev_b32 v48, 16, v23
    v_and_b32 v49, 0xffff0000, v23
    v_lshlrev_b32 v50, 16, v24
    v_and_b32 v51, 0xffff0000, v24
    v_lshlrev_b32 v52, 16, v25
    v_and_b32 v53, 0xffff0000, v25
    v_lshlrev_b32 v54, 16, v26
    v_and_b32 v55, 0xffff0000, v26
    v_add_f32 v36, v36, v46
    v_add_f32 v37, v37, v47
    v_add_f32 v38, v38, v48
    v_add_f32 v39, v39, v49
    v_add_f32 v40, v40, v50
    v_add_f32 v41, v41, v51
    v_add_f32 v42, v42, v52
    v_add_f32 v43, v43, v53
    v_add_f32 v44, v44, v54
    v_add_f32 v45, v45, v55
    v_cvt_pk_bf16_f32 v16, v36, v37
    v_cvt_pk_bf16_f32 v17, v38, v39
    v_cvt_pk_bf16_f32 v18, v40, v41
    v_cvt_pk_bf16_f32 v19, v42, v43
    v_cvt_pk_bf16_f32 v20, v44, v45
    ds_write_b64 v78, v[16:17]
    ds_write_b64 v78, v[18:19] offset:16
    ds_write_b32 v79, v20
    s_waitcnt lgkmcnt(0)
    s_mov_b64 exec, 1
    ds_add_u32 v2, v0 offset:2904
    s_mov_b64 exec, -1
L_D_A4:
    s_cmp_lt_u32 s2, 60
    s_cselect_b32 s11, 0, 2048
    s_lshl_b32 s4, s2, 9
    s_add_u32 s11, s11, s4
    v_and_b32 v8, 3, v1
    v_lshlrev_b32 v6, 5, v8
    v_lshrrev_b32 v8, 4, v1
    v_lshl_add_u32 v6, v8, 3, v6
    s_lshl_b32 s4, s3, 7
    s_add_u32 s11, s11, s4
    s_mov_b32 s12, 0x000f000f
    s_mov_b32 s13, 0x000f000f
    s_mov_b32 s5, 0
Lsp_52:
    ds_read_b32 v8, v2 offset:2904
    s_add_u32 s5, s5, 1
    s_waitcnt lgkmcnt(0)
    v_readfirstlane_b32 s4, v8
    s_nop 0
    s_cmp_ge_u32 s4, 4
    s_nop 1
    s_cbranch_scc1 Lspd_53
    s_sleep 1
    s_cmp_lt_u32 s5, 1048576
    s_cbranch_scc1 Lsp_52
Lspd_53:
    ds_read_b128 v[16:19], v5 offset:0
    ds_read_b128 v[20:23], v5 offset:64
    ds_read_b128 v[24:27], v5 offset:128
    ds_read_b128 v[28:31], v5 offset:192
    ds_read_b128 v[32:35], v5 offset:256
    ds_read_b128 v[36:39], v5 offset:320
    ds_read_b128 v[40:43], v5 offset:384
    ds_read_b128 v[44:47], v5 offset:448
    ds_read_b128 v[48:51], v5 offset:512
    ds_read_b128 v[52:55], v5 offset:576
    ds_read_b128 v[56:59], v5 offset:640
    ds_read_b128 v[60:63], v5 offset:704
    ds_read_b128 v[64:67], v5 offset:768
    ds_read_b128 v[68:71], v5 offset:832
    s_waitcnt lgkmcnt(13)
    v_mfma_f32_16x16x32_bf16 v[72:75], v[88:91], v[16:19], 0
    s_waitcnt lgkmcnt(12)
    v_mfma_f32_16x16x32_bf16 v[72:75], v[92:95], v[20:23], v[72:75]
    ds_read_b128 v[16:19], v5 offset:896
    s_waitcnt lgkmcnt(12)
    v_mfma_f32_16x16x32_bf16 v[72:75], v[96:99], v[24:27], v[72:75]
    ds_read_b128 v[20:23], v5 offset:960
    s_waitcnt lgkmcnt(12)
    v_mfma_f32_16x16x32_bf16 v[72:75], v[100:103], v[28:31], v[72:75]
    ds_read_b128 v[24:27], v5 offset:1024
    s_waitcnt lgkmcnt(12)
    v_mfma_f32_16x16x32_bf16 v[72:75], v[104:107], v[32:35], v[72:75]
    ds_read_b128 v[28:31], v5 offset:1088
    s_waitcnt lgkmcnt(12)
    v_mfma_f32_16x16x32_bf16 v[72:75], v[108:111], v[36:39], v[72:75]
    ds_read_b128 v[32:35], v5 offset:1152
    s_waitcnt lgkmcnt(12)
    v_mfma_f32_16x16x32_bf16 v[72:75], v[112:115], v[40:43], v[72:75]
    ds_read_b128 v[36:39], v5 offset:1216
    s_waitcnt lgkmcnt(12)
    v_mfma_f32_16x16x32_bf16 v[72:75], v[116:119], v[44:47], v[72:75]
    s_waitcnt lgkmcnt(11)
    v_mfma_f32_16x16x32_bf16 v[72:75], v[120:123], v[48:51], v[72:75]
    s_waitcnt lgkmcnt(10)
    v_mfma_f32_16x16x32_bf16 v[72:75], v[124:127], v[52:55], v[72:75]
    s_waitcnt lgkmcnt(9)
    v_mfma_f32_16x16x32_bf16 v[72:75], v[128:131], v[56:59], v[72:75]
    s_waitcnt lgkmcnt(8)
    v_mfma_f32_16x16x32_bf16 v[72:75], v[132:135], v[60:63], v[72:75]
    s_waitcnt lgkmcnt(7)
    v_mfma_f32_16x16x32_bf16 v[72:75], v[136:139], v[64:67], v[72:75]
    s_waitcnt lgkmcnt(6)
    v_mfma_f32_16x16x32_bf16 v[72:75], v[140:143], v[68:71], v[72:75]
    s_waitcnt lgkmcnt(5)
    v_mfma_f32_16x16x32_bf16 v[72:75], v[144:147], v[16:19], v[72:75]
    s_waitcnt lgkmcnt(4)
    v_mfma_f32_16x16x32_bf16 v[72:75], v[148:151], v[20:23], v[72:75]
    s_waitcnt lgkmcnt(3)
    v_mfma_f32_16x16x32_bf16 v[72:75], v[152:155], v[24:27], v[72:75]
    s_waitcnt lgkmcnt(2)
    v_mfma_f32_16x16x32_bf16 v[72:75], v[156:159], v[28:31], v[72:75]
    s_waitcnt lgkmcnt(1)
    v_mfma_f32_16x16x32_bf16 v[72:75], v[160:163], v[32:35], v[72:75]
    s_waitcnt lgkmcnt(0)
    v_mfma_f32_16x16x32_bf16 v[72:75], v[164:167], v[36:39], v[72:75]
    s_nop 7
    v_cvt_pk_bf16_f32 v16, v72, v73
    v_cvt_pk_bf16_f32 v17, v74, v75
    v_min_u32 v16, -2, v16
    v_min_u32 v17, -2, v17
    s_mov_b64 exec, s[12:13]
    buffer_store_dwordx2 v[16:17], v6, s[52:55], s11 offen sc1
    s_mov_b64 exec, -1
    s_mov_b64 exec, 1
    ds_add_u32 v2, v0 offset:2932
    s_mov_b64 exec, -1
L_D_noA:
    s_cmp_lg_u32 s3, 0
    s_cbranch_scc1 L_D_noq
    s_mov_b32 s5, 0
Lsp_54:
    ds_read_b32 v8, v2 offset:2920
    s_add_u32 s5, s5, 1
    s_waitcnt lgkmcnt(0)
    v_readfirstlane_b32 s4, v8
    s_nop 0
    s_cmp_ge_u32 s4, 1
    s_nop 1
    s_cbranch_scc1 Lspd_55
    s_sleep 1
    s_cmp_lt_u32 s5, 1048576
    s_cbranch_scc1 Lsp_54
Lspd_55:
    s_bfe_u32 s6, s68, 0x20005
    s_mov_b32 s7, s69
    s_lshl_b32 s8, s6, 5
    s_mul_i32 s9, s7, 1536
    s_add_u32 s8, s8, s9
    s_add_u32 s8, s8, 32768
    v_lshrrev_b32 v9, 1, v1
    v_lshlrev_b32 v10, 7, v9
    v_and_b32 v9, 1, v1
    v_lshl_add_u32 v10, v9, 4, v10
    v_lshlrev_b32 v9, 4, v1
    s_mov_b64 exec, 0xffffff
    s_mov_b32 s5, 0
Lpl_56:
    buffer_load_dwordx4 v[16:19], v10, s[52:55], s8 offen sc1
    s_add_u32 s5, s5, 1
    s_waitcnt vmcnt(0)
    v_max3_u32 v8, v16, v17, v18
    v_max_u32 v8, v8, v19
    v_cmp_eq_u32 vcc, -1, v8
    s_nop 3
    s_cbranch_vccz Lpld_57
    s_sleep 2
    s_cmp_lt_u32 s5, 1048576
    s_cbranch_scc1 Lpl_56
Lpld_57:
    v_add_u32 v9, 111104, v9
    ds_write_b128 v9, v[16:19]
    s_waitcnt lgkmcnt(0)
    s_mov_b64 exec, 1
    ds_add_u32 v2, v0 offset:2888
    s_mov_b64 exec, -1
L_D_noq:
    s_cmp_ge_u32 s2, 236
    s_cbranch_scc1 L_D_P6
    s_cmp_ge_u32 s2, 156
    s_cbranch_scc1 L_D_P4
    s_cmp_lt_u32 s2, 20
    s_cbranch_scc1 L_D_end
    s_cmp_ge_u32 s2, 68
    s_cbranch_scc1 L_D_end
    s_mov_b32 s5, 0
Lsp_58:
    ds_read_b32 v8, v2 offset:2884
    s_add_u32 s5, s5, 1
    s_waitcnt lgkmcnt(0)
    v_readfirstlane_b32 s4, v8
    s_nop 0
    s_cmp_ge_u32 s4, 8
    s_nop 1
    s_cbranch_scc1 Lspd_59
    s_sleep 2
    s_cmp_lt_u32 s5, 1048576
    s_cbranch_scc1 Lsp_58
Lspd_59:
    ds_read_b64_tr_b16 v[88:89], v3 offset:0
    ds_read_b64_tr_b16 v[90:91], v3 offset:2048
    ds_read_b64_tr_b16 v[92:93], v3 offset:4096
    ds_read_b64_tr_b16 v[94:95], v3 offset:6144
    ds_read_b64_tr_b16 v[96:97], v3 offset:8192
    ds_read_b64_tr_b16 v[98:99], v3 offset:10240
    ds_read_b64_tr_b16 v[100:101], v3 offset:12288
    ds_read_b64_tr_b16 v[102:103], v3 offset:14336
    ds_read_b64_tr_b16 v[104:105], v3 offset:16384
    ds_read_b64_tr_b16 v[106:107], v3 offset:18432
    ds_read_b64_tr_b16 v[108:109], v3 offset:20480
    ds_read_b64_tr_b16 v[110:111], v3 offset:22528
    ds_read_b64_tr_b16 v[112:113], v3 offset:24576
    ds_read_b64_tr_b16 v[114:115], v3 offset:26624
    ds_read_b64_tr_b16 v[116:117], v3 offset:28672
    ds_read_b64_tr_b16 v[118:119], v3 offset:30720
    ds_read_b64_tr_b16 v[120:121], v3 offset:32768
    ds_read_b64_tr_b16 v[122:123], v3 offset:34816
    ds_read_b64_tr_b16 v[124:125], v3 offset:36864
    ds_read_b64_tr_b16 v[126:127], v3 offset:38912
    ds_read_b64_tr_b16 v[128:129], v4 offset:0
    ds_read_b64_tr_b16 v[130:131], v4 offset:2048
    ds_read_b64_tr_b16 v[132:133], v4 offset:4096
    ds_read_b64_tr_b16 v[134:135], v4 offset:6144
    ds_read_b64_tr_b16 v[136:137], v4 offset:8192
    ds_read_b64_tr_b16 v[138:139], v4 offset:10240
    ds_read_b64_tr_b16 v[140:141], v4 offset:12288
    ds_read_b64_tr_b16 v[142:143], v4 offset:14336
    ds_read_b64_tr_b16 v[144:145], v4 offset:16384
    ds_read_b64_tr_b16 v[146:147], v4 offset:18432
    ds_read_b64_tr_b16 v[148:149], v4 offset:20480
    ds_read_b64_tr_b16 v[150:151], v4 offset:22528
    ds_read_b64_tr_b16 v[152:153], v4 offset:24576
    ds_read_b64_tr_b16 v[154:155], v4 offset:26624
    ds_read_b64_tr_b16 v[156:157], v4 offset:28672
    ds_read_b64_tr_b16 v[158:159], v4 offset:30720
    ds_read_b64_tr_b16 v[160:161], v4 offset:32768
    ds_read_b64_tr_b16 v[162:163], v4 offset:34816
    ds_read_b64_tr_b16 v[164:165], v4 offset:36864
    ds_read_b64_tr_b16 v[166:167], v4 offset:38912
    s_waitcnt lgkmcnt(0)
    s_lshl_b32 s11, s2, 9
    s_add_u32 s11, s11, 284672
    v_and_b32 v8, 7, v1
    v_mul_u32_u24 v84, 1344, v8
    v_lshrrev_b32 v9, 4, v1
    v_lshl_add_u32 v84, v9, 4, v84
    v_add_u32 v84, 135168, v84
    v_and_b32 v8, 3, v1
    v_lshl_add_u32 v85, v8, 3, v2
    s_mov_b32 s5, 0
Lsp_60:
    ds_read_b32 v8, v2 offset:2944
    s_add_u32 s5, s5, 1
    s_waitcnt lgkmcnt(0)
    v_readfirstlane_b32 s4, v8
    s_nop 0
    s_cmp_ge_u32 s4, 4
    s_nop 1
    s_cbranch_scc1 Lspd_61
    s_sleep 2
    s_cmp_lt_u32 s5, 1048576
    s_cbranch_scc1 Lsp_60
Lspd_61:
    ds_read_b128 v[16:19], v84 offset:0
    ds_read_b128 v[20:23], v84 offset:64
    ds_read_b128 v[24:27], v84 offset:128
    ds_read_b128 v[28:31], v84 offset:192
    ds_read_b128 v[32:35], v84 offset:256
    ds_read_b128 v[36:39], v84 offset:320
    ds_read_b128 v[40:43], v84 offset:384
    ds_read_b128 v[44:47], v84 offset:448
    ds_read_b128 v[48:51], v84 offset:512
    ds_read_b128 v[52:55], v84 offset:576
    ds_read_b128 v[56:59], v84 offset:640
    ds_read_b128 v[60:63], v84 offset:704
    ds_read_b128 v[64:67], v84 offset:768
    ds_read_b128 v[68:71], v84 offset:832
    s_waitcnt lgkmcnt(13)
    v_mfma_f32_16x16x32_bf16 v[76:79], v[88:91], v[16:19], 0
    s_waitcnt lgkmcnt(12)
    v_mfma_f32_16x16x32_bf16 v[76:79], v[92:95], v[20:23], v[76:79]
    ds_read_b128 v[16:19], v84 offset:896
    s_waitcnt lgkmcnt(12)
    v_mfma_f32_16x16x32_bf16 v[76:79], v[96:99], v[24:27], v[76:79]
    ds_read_b128 v[20:23], v84 offset:960
    s_waitcnt lgkmcnt(12)
    v_mfma_f32_16x16x32_bf16 v[76:79], v[100:103], v[28:31], v[76:79]
    ds_read_b128 v[24:27], v84 offset:1024
    s_waitcnt lgkmcnt(12)
    v_mfma_f32_16x16x32_bf16 v[76:79], v[104:107], v[32:35], v[76:79]
    ds_read_b128 v[28:31], v84 offset:1088
    s_waitcnt lgkmcnt(12)
    v_mfma_f32_16x16x32_bf16 v[76:79], v[108:111], v[36:39], v[76:79]
    ds_read_b128 v[32:35], v84 offset:1152
    s_waitcnt lgkmcnt(12)
    v_mfma_f32_16x16x32_bf16 v[76:79], v[112:115], v[40:43], v[76:79]
    ds_read_b128 v[36:39], v84 offset:1216
    s_waitcnt lgkmcnt(12)
    v_mfma_f32_16x16x32_bf16 v[76:79], v[116:119], v[44:47], v[76:79]
    s_waitcnt lgkmcnt(11)
    v_mfma_f32_16x16x32_bf16 v[76:79], v[120:123], v[48:51], v[76:79]
    s_waitcnt lgkmcnt(10)
    v_mfma_f32_16x16x32_bf16 v[76:79], v[124:127], v[52:55], v[76:79]
    s_waitcnt lgkmcnt(9)
    v_mfma_f32_16x16x32_bf16 v[76:79], v[128:131], v[56:59], v[76:79]
    s_waitcnt lgkmcnt(8)
    v_mfma_f32_16x16x32_bf16 v[76:79], v[132:135], v[60:63], v[76:79]
    s_waitcnt lgkmcnt(7)
    v_mfma_f32_16x16x32_bf16 v[76:79], v[136:139], v[64:67], v[76:79]
    s_waitcnt lgkmcnt(6)
    v_mfma_f32_16x16x32_bf16 v[76:79], v[140:143], v[68:71], v[76:79]
    s_waitcnt lgkmcnt(5)
    v_mfma_f32_16x16x32_bf16 v[76:79], v[144:147], v[16:19], v[76:79]
    s_waitcnt lgkmcnt(4)
    v_mfma_f32_16x16x32_bf16 v[76:79], v[148:151], v[20:23], v[76:79]
    s_waitcnt lgkmcnt(3)
    v_mfma_f32_16x16x32_bf16 v[76:79], v[152:155], v[24:27], v[76:79]
    s_waitcnt lgkmcnt(2)
    v_mfma_f32_16x16x32_bf16 v[76:79], v[156:159], v[28:31], v[76:79]
    s_waitcnt lgkmcnt(1)
    v_mfma_f32_16x16x32_bf16 v[76:79], v[160:163], v[32:35], v[76:79]
    s_waitcnt lgkmcnt(0)
    v_mfma_f32_16x16x32_bf16 v[76:79], v[164:167], v[36:39], v[76:79]
    s_nop 7
    v_mov_b32_dpp v80, v76 row_shl:4 row_mask:0xf bank_mask:0xf
    v_mov_b32_dpp v81, v77 row_shl:4 row_mask:0xf bank_mask:0xf
    v_mov_b32_dpp v82, v78 row_shl:4 row_mask:0xf bank_mask:0xf
    v_mov_b32_dpp v83, v79 row_shl:4 row_mask:0xf bank_mask:0xf
    v_and_b32 v8, 3, v1
    v_lshlrev_b32 v6, 5, v8
    v_lshrrev_b32 v8, 4, v1
    v_lshl_add_u32 v6, v8, 3, v6
    s_lshl_b32 s4, s3, 7
    s_add_u32 s11, s11, s4
    s_mov_b32 s12, 0x000f000f
    s_mov_b32 s13, 0x000f000f
    s_mov_b32 s5, 0
Lsp_62:
    ds_read_b32 v8, v2 offset:2916
    s_add_u32 s5, s5, 1
    s_waitcnt lgkmcnt(0)
    v_readfirstlane_b32 s4, v8
    s_nop 0
    s_cmp_ge_u32 s4, 4
    s_nop 1
    s_cbranch_scc1 Lspd_63
    s_cmp_lt_u32 s5, 1048576
    s_cbranch_scc1 Lsp_62
Lspd_63:
    ds_read_b128 v[16:19], v5 offset:0
    ds_read_b128 v[20:23], v5 offset:64
    ds_read_b128 v[24:27], v5 offset:128
    ds_read_b128 v[28:31], v5 offset:192
    ds_read_b128 v[32:35], v5 offset:256
    ds_read_b128 v[36:39], v5 offset:320
    ds_read_b128 v[40:43], v5 offset:384
    ds_read_b128 v[44:47], v5 offset:448
    ds_read_b128 v[48:51], v5 offset:512
    ds_read_b128 v[52:55], v5 offset:576
    ds_read_b128 v[56:59], v5 offset:640
    ds_read_b128 v[60:63], v5 offset:704
    ds_read_b128 v[64:67], v5 offset:768
    ds_read_b128 v[68:71], v5 offset:832
    s_waitcnt lgkmcnt(13)
    v_mfma_f32_16x16x32_bf16 v[72:75], v[88:91], v[16:19], 0
    s_waitcnt lgkmcnt(12)
    v_mfma_f32_16x16x32_bf16 v[72:75], v[92:95], v[20:23], v[72:75]
    ds_read_b128 v[16:19], v5 offset:896
    s_waitcnt lgkmcnt(12)
    v_mfma_f32_16x16x32_bf16 v[72:75], v[96:99], v[24:27], v[72:75]
    ds_read_b128 v[20:23], v5 offset:960
    s_waitcnt lgkmcnt(12)
    v_mfma_f32_16x16x32_bf16 v[72:75], v[100:103], v[28:31], v[72:75]
    ds_read_b128 v[24:27], v5 offset:1024
    s_waitcnt lgkmcnt(12)
    v_mfma_f32_16x16x32_bf16 v[72:75], v[104:107], v[32:35], v[72:75]
    ds_read_b128 v[28:31], v5 offset:1088
    s_waitcnt lgkmcnt(12)
    v_mfma_f32_16x16x32_bf16 v[72:75], v[108:111], v[36:39], v[72:75]
    ds_read_b128 v[32:35], v5 offset:1152
    s_waitcnt lgkmcnt(12)
    v_mfma_f32_16x16x32_bf16 v[72:75], v[112:115], v[40:43], v[72:75]
    ds_read_b128 v[36:39], v5 offset:1216
    s_waitcnt lgkmcnt(12)
    v_mfma_f32_16x16x32_bf16 v[72:75], v[116:119], v[44:47], v[72:75]
    s_waitcnt lgkmcnt(11)
    v_mfma_f32_16x16x32_bf16 v[72:75], v[120:123], v[48:51], v[72:75]
    s_waitcnt lgkmcnt(10)
    v_mfma_f32_16x16x32_bf16 v[72:75], v[124:127], v[52:55], v[72:75]
    s_waitcnt lgkmcnt(9)
    v_mfma_f32_16x16x32_bf16 v[72:75], v[128:131], v[56:59], v[72:75]
    s_waitcnt lgkmcnt(8)
    v_mfma_f32_16x16x32_bf16 v[72:75], v[132:135], v[60:63], v[72:75]
    s_waitcnt lgkmcnt(7)
    v_mfma_f32_16x16x32_bf16 v[72:75], v[136:139], v[64:67], v[72:75]
    s_waitcnt lgkmcnt(6)
    v_mfma_f32_16x16x32_bf16 v[72:75], v[140:143], v[68:71], v[72:75]
    s_waitcnt lgkmcnt(5)
    v_mfma_f32_16x16x32_bf16 v[72:75], v[144:147], v[16:19], v[72:75]
    s_waitcnt lgkmcnt(4)
    v_mfma_f32_16x16x32_bf16 v[72:75], v[148:151], v[20:23], v[72:75]
    s_waitcnt lgkmcnt(3)
    v_mfma_f32_16x16x32_bf16 v[72:75], v[152:155], v[24:27], v[72:75]
    s_waitcnt lgkmcnt(2)
    v_mfma_f32_16x16x32_bf16 v[72:75], v[156:159], v[28:31], v[72:75]
    s_waitcnt lgkmcnt(1)
    v_mfma_f32_16x16x32_bf16 v[72:75], v[160:163], v[32:35], v[72:75]
    s_waitcnt lgkmcnt(0)
    v_mfma_f32_16x16x32_bf16 v[72:75], v[164:167], v[36:39], v[72:75]
    s_mov_b32 s5, 0
Lsp_64:
    ds_read_b32 v8, v2 offset:2948
    s_add_u32 s5, s5, 1
    s_waitcnt lgkmcnt(0)
    v_readfirstlane_b32 s4, v8
    s_nop 0
    s_cmp_ge_u32 s4, 4
    s_nop 1
    s_cbranch_scc1 Lspd_65
    s_cmp_lt_u32 s5, 1048576
    s_cbranch_scc1 Lsp_64
Lspd_65:
    ds_read_b64 v[16:17], v85 offset:2976
    s_waitcnt lgkmcnt(0)
    v_fma_f32 v72, -v17, v76, v72
    v_fma_f32 v73, -v17, v77, v73
    v_fma_f32 v74, -v17, v78, v74
    v_fma_f32 v75, -v17, v79, v75
    v_fma_f32 v72, v16, v72, v80
    v_fma_f32 v73, v16, v73, v81
    v_fma_f32 v74, v16, v74, v82
    v_fma_f32 v75, v16, v75, v83
    v_cvt_pk_bf16_f32 v16, v72, v73
    v_cvt_pk_bf16_f32 v17, v74, v75
    v_min_u32 v16, -2, v16
    v_min_u32 v17, -2, v17
    s_mov_b64 exec, s[12:13]
    buffer_store_dwordx2 v[16:17], v6, s[52:55], s11 offen sc1
    s_mov_b64 exec, -1
    s_branch L_D_end
L_D_P4:
    s_waitcnt vmcnt(0)
    s_and_b32 s14, s68, 7
    s_sub_u32 s15, s68, 160
    s_lshr_b32 s15, s15, 3
    s_lshl_b32 s7, s14, 2
    s_add_u32 s7, s7, s3
    v_lshrrev_b32 v9, 2, v1
    v_lshlrev_b32 v3, 7, v9
    v_bfe_u32 v9, v1, 3, 2
    v_lshl_add_u32 v3, v9, 5, v3
    v_and_b32 v9, 3, v1
    v_lshl_add_u32 v3, v9, 3, v3
    v_lshrrev_b32 v9, 2, v1
    v_lshlrev_b32 v4, 7, v9
    v_bfe_u32 v9, v1, 3, 2
    v_xor_b32 v9, 1, v9
    v_lshl_add_u32 v4, v9, 5, v4
    v_and_b32 v9, 3, v1
    v_lshl_add_u32 v4, v9, 3, v4
    v_lshrrev_b32 v9, 2, v1
    v_lshlrev_b32 v5, 7, v9
    v_bfe_u32 v9, v1, 3, 2
    v_xor_b32 v9, 2, v9
    v_lshl_add_u32 v5, v9, 5, v5
    v_and_b32 v9, 3, v1
    v_lshl_add_u32 v5, v9, 3, v5
    v_lshrrev_b32 v9, 2, v1
    v_lshlrev_b32 v6, 7, v9
    v_bfe_u32 v9, v1, 3, 2
    v_xor_b32 v9, 3, v9
    v_lshl_add_u32 v6, v9, 5, v6
    v_and_b32 v9, 3, v1
    v_lshl_add_u32 v6, v9, 3, v6
    s_mul_i32 s4, s3, 24576
    v_add_u32 v3, s4, v3
    v_add_u32 v4, s4, v4
    v_add_u32 v5, s4, v5
    v_add_u32 v6, s4, v6
    v_lshrrev_b32 v9, 4, v1
    v_and_b32 v10, 7, v1
    v_mul_u32_u24 v68, 416, v10
    s_mul_i32 s10, s3, 6656
    s_add_u32 s10, s10, 135168
    v_add_u32 v68, s10, v68
    v_lshl_add_u32 v64, v9, 4, v68
    s_lshl_b32 s8, s7, 12
    s_add_u32 s8, s8, 81920
    v_lshlrev_b32 v65, 6, v10
    v_bfe_u32 v10, v1, 3, 1
    v_lshl_add_u32 v65, v10, 4, v65
    v_lshl_add_u32 v65, v9, 2, v65
    v_lshlrev_b32 v65, 2, v65
    s_lshl_b32 s4, s3, 11
    s_add_u32 s4, s4, 126976
    v_add_u32 v65, s4, v65
    v_lshlrev_b32 v67, 4, v1
    v_add_u32 v66, 126976, v67
    s_mul_i32 s9, s14, 5120
    s_lshl_b32 s4, s15, 9
    s_add_u32 s9, s9, s4
    s_add_u32 s9, s9, 212992
    v_lshlrev_b32 v69, 3, v1
    s_mov_b32 s5, 0
Lsp_66:
    ds_read_b32 v8, v2 offset:2884
    s_add_u32 s5, s5, 1
    s_waitcnt lgkmcnt(0)
    v_readfirstlane_b32 s4, v8
    s_nop 0
    s_cmp_ge_u32 s4, 8
    s_nop 1
    s_cbranch_scc1 Lspd_67
    s_sleep 2
    s_cmp_lt_u32 s5, 1048576
    s_cbranch_scc1 Lsp_66
Lspd_67:
    ds_read_b64_tr_b16 v[72:73], v3 offset:0
    ds_read_b64_tr_b16 v[74:75], v3 offset:2048
    ds_read_b64_tr_b16 v[76:77], v4 offset:0
    ds_read_b64_tr_b16 v[78:79], v4 offset:2048
    ds_read_b64_tr_b16 v[80:81], v5 offset:0
    ds_read_b64_tr_b16 v[82:83], v5 offset:2048
    ds_read_b64_tr_b16 v[84:85], v6 offset:0
    ds_read_b64_tr_b16 v[86:87], v6 offset:2048
    ds_read_b64_tr_b16 v[88:89], v3 offset:4096
    ds_read_b64_tr_b16 v[90:91], v3 offset:6144
    ds_read_b64_tr_b16 v[92:93], v4 offset:4096
    ds_read_b64_tr_b16 v[94:95], v4 offset:6144
    ds_read_b64_tr_b16 v[96:97], v5 offset:4096
    ds_read_b64_tr_b16 v[98:99], v5 offset:6144
    ds_read_b64_tr_b16 v[100:101], v6 offset:4096
    ds_read_b64_tr_b16 v[102:103], v6 offset:6144
    ds_read_b64_tr_b16 v[104:105], v3 offset:8192
    ds_read_b64_tr_b16 v[106:107], v3 offset:10240
    ds_read_b64_tr_b16 v[108:109], v4 offset:8192
    ds_read_b64_tr_b16 v[110:111], v4 offset:10240
    ds_read_b64_tr_b16 v[112:113], v5 offset:8192
    ds_read_b64_tr_b16 v[114:115], v5 offset:10240
    ds_read_b64_tr_b16 v[116:117], v6 offset:8192
    ds_read_b64_tr_b16 v[118:119], v6 offset:10240
    ds_read_b64_tr_b16 v[120:121], v3 offset:12288
    ds_read_b64_tr_b16 v[122:123], v3 offset:14336
    ds_read_b64_tr_b16 v[124:125], v4 offset:12288
    ds_read_b64_tr_b16 v[126:127], v4 offset:14336
    ds_read_b64_tr_b16 v[128:129], v5 offset:12288
    ds_read_b64_tr_b16 v[130:131], v5 offset:14336
    ds_read_b64_tr_b16 v[132:133], v6 offset:12288
    ds_read_b64_tr_b16 v[134:135], v6 offset:14336
    ds_read_b64_tr_b16 v[136:137], v3 offset:16384
    ds_read_b64_tr_b16 v[138:139], v3 offset:18432
    ds_read_b64_tr_b16 v[140:141], v4 offset:16384
    ds_read_b64_tr_b16 v[142:143], v4 offset:18432
    ds_read_b64_tr_b16 v[144:145], v5 offset:16384
    ds_read_b64_tr_b16 v[146:147], v5 offset:18432
    ds_read_b64_tr_b16 v[148:149], v6 offset:16384
    ds_read_b64_tr_b16 v[150:151], v6 offset:18432
    ds_read_b64_tr_b16 v[152:153], v3 offset:20480
    ds_read_b64_tr_b16 v[154:155], v3 offset:22528
    ds_read_b64_tr_b16 v[156:157], v4 offset:20480
    ds_read_b64_tr_b16 v[158:159], v4 offset:22528
    ds_read_b64_tr_b16 v[160:161], v5 offset:20480
    ds_read_b64_tr_b16 v[162:163], v5 offset:22528
    ds_read_b64_tr_b16 v[164:165], v6 offset:20480
    ds_read_b64_tr_b16 v[166:167], v6 offset:22528
    s_waitcnt lgkmcnt(0)
    s_mov_b32 s5, 0
Lsp_68:
    ds_read_b32 v8, v2 offset:2900
    s_add_u32 s5, s5, 1
    s_waitcnt lgkmcnt(0)
    v_readfirstlane_b32 s4, v8
    s_nop 0
    s_cmp_ge_u32 s4, 1
    s_nop 1
    s_cbranch_scc1 Lspd_69
    s_sleep 4
    s_cmp_lt_u32 s5, 1048576
    s_cbranch_scc1 Lsp_68
Lspd_69:
    s_mov_b32 s5, 0
    s_add_u32 s11, s8, 245760
    s_mov_b32 s12, 0xff
    s_mov_b32 s6, 0
L_P4_poll:
    s_add_u32 s6, s6, 1
    s_cmp_gt_u32 s6, 3
    s_cselect_b32 s4, s8, s11
    s_cselect_b32 s6, 0, s6
    s_mov_b64 exec, 0x1ffffff
    s_bitcmp1_b32 s12, 0
    s_cbranch_scc0 L_P4s_70
    s_add_u32 m0, s10, 0
    s_nop 0
    buffer_load_dwordx4 v67, s[52:55], s4 offen offset:0 sc1 lds
L_P4s_70:
    s_bitcmp1_b32 s12, 1
    s_cbranch_scc0 L_P4s_71
    s_add_u32 m0, s10, -96
    s_nop 0
    buffer_load_dwordx4 v67, s[52:55], s4 offen offset:512 sc1 lds
L_P4s_71:
    s_bitcmp1_b32 s12, 2
    s_cbranch_scc0 L_P4s_72
    s_add_u32 m0, s10, -192
    s_nop 0
    buffer_load_dwordx4 v67, s[52:55], s4 offen offset:1024 sc1 lds
L_P4s_72:
    s_bitcmp1_b32 s12, 3
    s_cbranch_scc0 L_P4s_73
    s_add_u32 m0, s10, -288
    s_nop 0
    buffer_load_dwordx4 v67, s[52:55], s4 offen offset:1536 sc1 lds
L_P4s_73:
    s_bitcmp1_b32 s12, 4
    s_cbranch_scc0 L_P4s_74
    s_add_u32 m0, s10, -384
    s_nop 0
    buffer_load_dwordx4 v67, s[52:55], s4 offen offset:2048 sc1 lds
L_P4s_74:
    s_bitcmp1_b32 s12, 5
    s_cbranch_scc0 L_P4s_75
    s_add_u32 m0, s10, -480
    s_nop 0
    buffer_load_dwordx4 v67, s[52:55], s4 offen offset:2560 sc1 lds
L_P4s_75:
    s_bitcmp1_b32 s12, 6
    s_cbranch_scc0 L_P4s_76
    s_add_u32 m0, s10, -576
    s_nop 0
    buffer_load_dwordx4 v67, s[52:55], s4 offen offset:3072 sc1 lds
L_P4s_76:
    s_bitcmp1_b32 s12, 7
    s_cbranch_scc0 L_P4s_77
    s_add_u32 m0, s10, -672
    s_nop 0
    buffer_load_dwordx4 v67, s[52:55], s4 offen offset:3584 sc1 lds
L_P4s_77:
    s_mov_b64 exec, -1
    s_add_u32 s5, s5, 1
    s_waitcnt vmcnt(0)
    ds_read_b64 v[70:71], v68 offset:384
    ds_read_b128 v[16:19], v64 offset:0
    ds_read_b128 v[20:23], v64 offset:64
    ds_read_b128 v[24:27], v64 offset:128
    ds_read_b128 v[28:31], v64 offset:192
    ds_read_b128 v[32:35], v64 offset:256
    ds_read_b128 v[36:39], v64 offset:320
    s_waitcnt lgkmcnt(0)
    v_max3_u32 v8, v16, v17, v18
    v_max3_u32 v8, v8, v19, v20
    v_max3_u32 v8, v8, v21, v22
    v_max3_u32 v8, v8, v23, v24
    v_max3_u32 v8, v8, v25, v26
    v_max3_u32 v8, v8, v27, v28
    v_max3_u32 v8, v8, v29, v30
    v_max3_u32 v8, v8, v31, v32
    v_max3_u32 v8, v8, v33, v34
    v_max3_u32 v8, v8, v35, v36
    v_max3_u32 v8, v8, v37, v38
    v_max3_u32 v8, v8, v39, v70
    v_max_u32 v8, v8, v71
    v_cmp_eq_u32 vcc, -1, v8
    s_nop 3
    s_cbranch_vccz L_P4_ok
    s_or_b32 s12, vcc_lo, vcc_hi
    s_lshr_b32 s13, s12, 16
    s_or_b32 s12, s12, s13
    s_lshr_b32 s13, s12, 8
    s_or_b32 s12, s12, s13
    s_cmp_lt_u32 s5, 1048576
    s_cbranch_scc1 L_P4_poll
L_P4_ok:
    v_mfma_f32_16x16x32_bf16 v[40:43], v[72:75], v[16:19], 0
    v_mov_b32_dpp v9, v70 row_ror:4 row_mask:0xf bank_mask:0xf
    v_mfma_f32_16x16x32_bf16 v[44:47], v[76:79], v[16:19], 0
    v_mov_b32_dpp v10, v71 row_ror:4 row_mask:0xf bank_mask:0xf
    v_mfma_f32_16x16x32_bf16 v[48:51], v[80:83], v[16:19], 0
    v_max_f32 v11, v70, v9
    v_mfma_f32_16x16x32_bf16 v[52:55], v[84:87], v[16:19], 0
    v_sub_f32 v70, v70, v11
    v_mfma_f32_16x16x32_bf16 v[40:43], v[88:91], v[20:23], v[40:43]
    v_sub_f32 v9, v9, v11
    v_mfma_f32_16x16x32_bf16 v[44:47], v[92:95], v[20:23], v[44:47]
    v_mul_f32 v70, 0x3fb8aa3b, v70
    v_mfma_f32_16x16x32_bf16 v[48:51], v[96:99], v[20:23], v[48:51]
    v_mul_f32 v9, 0x3fb8aa3b, v9
    v_mfma_f32_16x16x32_bf16 v[52:55], v[100:103], v[20:23], v[52:55]
    v_exp_f32 v70, v70
    v_mfma_f32_16x16x32_bf16 v[40:43], v[104:107], v[24:27], v[40:43]
    v_exp_f32 v9, v9
    v_mfma_f32_16x16x32_bf16 v[44:47], v[108:111], v[24:27], v[44:47]
    v_mul_f32 v71, v71, v70
    v_mfma_f32_16x16x32_bf16 v[48:51], v[112:115], v[24:27], v[48:51]
    v_fmac_f32 v71, v10, v9
    v_mfma_f32_16x16x32_bf16 v[52:55], v[116:119], v[24:27], v[52:55]
    v_rcp_f32 v71, v71
    v_mfma_f32_16x16x32_bf16 v[40:43], v[120:123], v[28:31], v[40:43]
    v_mul_f32 v7, v70, v71
    v_mfma_f32_16x16x32_bf16 v[44:47], v[124:127], v[28:31], v[44:47]
    v_mfma_f32_16x16x32_bf16 v[48:51], v[128:131], v[28:31], v[48:51]
    v_mfma_f32_16x16x32_bf16 v[52:55], v[132:135], v[28:31], v[52:55]
    v_mfma_f32_16x16x32_bf16 v[40:43], v[136:139], v[32:35], v[40:43]
    v_mfma_f32_16x16x32_bf16 v[44:47], v[140:143], v[32:35], v[44:47]
    v_mfma_f32_16x16x32_bf16 v[48:51], v[144:147], v[32:35], v[48:51]
    v_mfma_f32_16x16x32_bf16 v[52:55], v[148:151], v[32:35], v[52:55]
    v_mfma_f32_16x16x32_bf16 v[40:43], v[152:155], v[36:39], v[40:43]
    v_mfma_f32_16x16x32_bf16 v[44:47], v[156:159], v[36:39], v[44:47]
    v_mfma_f32_16x16x32_bf16 v[48:51], v[160:163], v[36:39], v[48:51]
    v_mfma_f32_16x16x32_bf16 v[52:55], v[164:167], v[36:39], v[52:55]
    s_nop 4
    v_mul_f32_dpp v56, v40, v7 quad_perm:[0,1,2,3] row_mask:0xf bank_mask:0x3
    v_mul_f32_dpp v57, v41, v7 quad_perm:[0,1,2,3] row_mask:0xf bank_mask:0x3
    v_mul_f32_dpp v58, v42, v7 quad_perm:[0,1,2,3] row_mask:0xf bank_mask:0x3
    v_mul_f32_dpp v59, v43, v7 quad_perm:[0,1,2,3] row_mask:0xf bank_mask:0x3
    v_mul_f32_dpp v56, v44, v7 quad_perm:[0,1,2,3] row_mask:0xf bank_mask:0xc
    v_mul_f32_dpp v57, v45, v7 quad_perm:[0,1,2,3] row_mask:0xf bank_mask:0xc
    v_mul_f32_dpp v58, v46, v7 quad_perm:[0,1,2,3] row_mask:0xf bank_mask:0xc
    v_mul_f32_dpp v59, v47, v7 quad_perm:[0,1,2,3] row_mask:0xf bank_mask:0xc
    v_mul_f32_dpp v60, v48, v7 quad_perm:[0,1,2,3] row_mask:0xf bank_mask:0x3
    v_mul_f32_dpp v61, v49, v7 quad_perm:[0,1,2,3] row_mask:0xf bank_mask:0x3
    v_mul_f32_dpp v62, v50, v7 quad_perm:[0,1,2,3] row_mask:0xf bank_mask:0x3
    v_mul_f32_dpp v63, v51, v7 quad_perm:[0,1,2,3] row_mask:0xf bank_mask:0x3
    v_mul_f32_dpp v60, v52, v7 quad_perm:[0,1,2,3] row_mask:0xf bank_mask:0xc
    v_mul_f32_dpp v61, v53, v7 quad_perm:[0,1,2,3] row_mask:0xf bank_mask:0xc
    v_mul_f32_dpp v62, v54, v7 quad_perm:[0,1,2,3] row_mask:0xf bank_mask:0xc
    v_mul_f32_dpp v63, v55, v7 quad_perm:[0,1,2,3] row_mask:0xf bank_mask:0xc
    ds_write_b128 v65, v[56:59] offset:0
    ds_write_b128 v65, v[60:63] offset:128
    s_mov_b64 exec, 1
    ds_add_rtn_u32 v8, v2, v0 offset:2912
    s_mov_b64 exec, -1
    s_waitcnt lgkmcnt(0)
    v_readfirstlane_b32 s4, v8
    s_nop 0
    s_cmp_lg_u32 s4, 3
    s_nop 1
    s_cbranch_scc1 L_D_end
    ds_read_b128 v[16:19], v66 offset:0
    ds_read_b128 v[20:23], v66 offset:1024
    ds_read_b128 v[24:27], v66 offset:2048
    ds_read_b128 v[28:31], v66 offset:3072
    ds_read_b128 v[32:35], v66 offset:4096
    ds_read_b128 v[36:39], v66 offset:5120
    ds_read_b128 v[40:43], v66 offset:6144
    ds_read_b128 v[44:47], v66 offset:7168
    s_waitcnt lgkmcnt(6)
    v_pk_add_f32 v[16:17], v[16:17], v[20:21]
    v_pk_add_f32 v[18:19], v[18:19], v[22:23]
    s_waitcnt lgkmcnt(5)
    v_pk_add_f32 v[16:17], v[16:17], v[24:25]
    v_pk_add_f32 v[18:19], v[18:19], v[26:27]
    s_waitcnt lgkmcnt(4)
    v_pk_add_f32 v[16:17], v[16:17], v[28:29]
    v_pk_add_f32 v[18:19], v[18:19], v[30:31]
    s_waitcnt lgkmcnt(3)
    v_pk_add_f32 v[16:17], v[16:17], v[32:33]
    v_pk_add_f32 v[18:19], v[18:19], v[34:35]
    s_waitcnt lgkmcnt(2)
    v_pk_add_f32 v[16:17], v[16:17], v[36:37]
    v_pk_add_f32 v[18:19], v[18:19], v[38:39]
    s_waitcnt lgkmcnt(1)
    v_pk_add_f32 v[16:17], v[16:17], v[40:41]
    v_pk_add_f32 v[18:19], v[18:19], v[42:43]
    s_waitcnt lgkmcnt(0)
    v_pk_add_f32 v[16:17], v[16:17], v[44:45]
    v_pk_add_f32 v[18:19], v[18:19], v[46:47]
    v_cvt_pk_bf16_f32 v20, v16, v17
    v_cvt_pk_bf16_f32 v21, v18, v19
    v_min_u32 v20, -2, v20
    v_min_u32 v21, -2, v21
    buffer_store_dwordx2 v[20:21], v69, s[52:55], s9 offen sc1
    s_branch L_D_end
L_D_P6:
    s_waitcnt vmcnt(0)
    s_mov_b32 s76, s38
    s_mov_b32 s77, s39
    s_mov_b32 s78, 5120
    s_mov_b32 s79, 0x00020000
    s_mov_b32 s7, 0
    v_mov_b32 v6, 0
    s_mov_b32 s5, 0
Lsp_78:
    ds_read_b32 v8, v2 offset:2920
    s_add_u32 s5, s5, 1
    s_waitcnt lgkmcnt(0)
    v_readfirstlane_b32 s4, v8
    s_nop 0
    s_cmp_ge_u32 s4, 1
    s_nop 1
    s_cbranch_scc1 Lspd_79
    s_sleep 1
    s_cmp_lt_u32 s5, 1048576
    s_cbranch_scc1 Lsp_78
Lspd_79:
    s_and_b32 s14, s3, 1
    s_lshr_b32 s15, s3, 1
    v_lshrrev_b32 v9, 2, v1
    v_lshlrev_b32 v3, 6, v9
    v_bfe_u32 v9, v1, 4, 1
    v_xor_b32 v9, s14, v9
    v_lshl_add_u32 v3, v9, 5, v3
    v_and_b32 v9, 3, v1
    v_lshl_add_u32 v3, v9, 3, v3
    s_mul_i32 s4, s15, 49152
    v_add_u32 v3, s4, v3
    v_mul_u32_u24 v4, 3136, v9
    v_lshrrev_b32 v10, 4, v1
    v_lshl_add_u32 v4, v10, 4, v4
    s_mul_i32 s4, s15, 1536
    s_add_u32 s4, s4, 98304
    v_add_u32 v4, s4, v4
    v_lshl_add_u32 v5, v10, 2, v9
    v_lshlrev_b32 v5, 4, v5
    s_lshl_b32 s4, s14, 8
    v_add_u32 v5, s4, v5
    v_add_u32 v5, v5, v2
    s_mov_b32 s5, 0
Lsp_80:
    ds_read_b32 v8, v2 offset:2884
    s_add_u32 s5, s5, 1
    s_waitcnt lgkmcnt(0)
    v_readfirstlane_b32 s4, v8
    s_nop 0
    s_cmp_ge_u32 s4, 8
    s_nop 1
    s_cbranch_scc1 Lspd_81
    s_sleep 2
    s_cmp_lt_u32 s5, 1048576
    s_cbranch_scc1 Lsp_80
Lspd_81:
    ds_read_b64_tr_b16 v[72:73], v3 offset:0
    ds_read_b64_tr_b16 v[74:75], v3 offset:1024
    ds_read_b64_tr_b16 v[76:77], v3 offset:2048
    ds_read_b64_tr_b16 v[78:79], v3 offset:3072
    ds_read_b64_tr_b16 v[80:81], v3 offset:4096
    ds_read_b64_tr_b16 v[82:83], v3 offset:5120
    ds_read_b64_tr_b16 v[84:85], v3 offset:6144
    ds_read_b64_tr_b16 v[86:87], v3 offset:7168
    ds_read_b64_tr_b16 v[88:89], v3 offset:8192
    ds_read_b64_tr_b16 v[90:91], v3 offset:9216
    ds_read_b64_tr_b16 v[92:93], v3 offset:10240
    ds_read_b64_tr_b16 v[94:95], v3 offset:11264
    ds_read_b64_tr_b16 v[96:97], v3 offset:12288
    ds_read_b64_tr_b16 v[98:99], v3 offset:13312
    ds_read_b64_tr_b16 v[100:101], v3 offset:14336
    ds_read_b64_tr_b16 v[102:103], v3 offset:15360
    ds_read_b64_tr_b16 v[104:105], v3 offset:16384
    ds_read_b64_tr_b16 v[106:107], v3 offset:17408
    ds_read_b64_tr_b16 v[108:109], v3 offset:18432
    ds_read_b64_tr_b16 v[110:111], v3 offset:19456
    ds_read_b64_tr_b16 v[112:113], v3 offset:20480
    ds_read_b64_tr_b16 v[114:115], v3 offset:21504
    ds_read_b64_tr_b16 v[116:117], v3 offset:22528
    ds_read_b64_tr_b16 v[118:119], v3 offset:23552
    ds_read_b64_tr_b16 v[120:121], v3 offset:24576
    ds_read_b64_tr_b16 v[122:123], v3 offset:25600
    ds_read_b64_tr_b16 v[124:125], v3 offset:26624
    ds_read_b64_tr_b16 v[126:127], v3 offset:27648
    ds_read_b64_tr_b16 v[128:129], v3 offset:28672
    ds_read_b64_tr_b16 v[130:131], v3 offset:29696
    ds_read_b64_tr_b16 v[132:133], v3 offset:30720
    ds_read_b64_tr_b16 v[134:135], v3 offset:31744
    ds_read_b64_tr_b16 v[136:137], v3 offset:32768
    ds_read_b64_tr_b16 v[138:139], v3 offset:33792
    ds_read_b64_tr_b16 v[140:141], v3 offset:34816
    ds_read_b64_tr_b16 v[142:143], v3 offset:35840
    ds_read_b64_tr_b16 v[144:145], v3 offset:36864
    ds_read_b64_tr_b16 v[146:147], v3 offset:37888
    ds_read_b64_tr_b16 v[148:149], v3 offset:38912
    ds_read_b64_tr_b16 v[150:151], v3 offset:39936
    ds_read_b64_tr_b16 v[152:153], v3 offset:40960
    ds_read_b64_tr_b16 v[154:155], v3 offset:41984
    ds_read_b64_tr_b16 v[156:157], v3 offset:43008
    ds_read_b64_tr_b16 v[158:159], v3 offset:44032
    ds_read_b64_tr_b16 v[160:161], v3 offset:45056
    ds_read_b64_tr_b16 v[162:163], v3 offset:46080
    ds_read_b64_tr_b16 v[164:165], v3 offset:47104
    ds_read_b64_tr_b16 v[166:167], v3 offset:48128
    s_waitcnt lgkmcnt(0)
    s_cmp_lg_u32 s15, 0
    s_cbranch_scc1 L_D_P6b
    s_sub_u32 s6, s2, 236
    s_lshl_b32 s6, s6, 5
    s_lshl_b32 s4, s14, 4
    s_add_u32 s6, s6, s4
    v_mul_u32_u24 v56, 1280, v9
    v_lshl_add_u32 v56, v10, 3, v56
    v_lshlrev_b32 v57, 5, v9
    v_lshl_add_u32 v57, v10, 3, v57
    v_lshlrev_b32 v58, 7, v9
    v_lshl_add_u32 v58, v10, 3, v58
    v_mov_b32 v6, v56
    s_mov_b32 s60, s16
    s_mov_b32 s61, s17
    s_mov_b32 s62, 5120
    s_mov_b32 s63, 0x00020000
    s_lshl_b32 s7, s6, 1
    s_mov_b32 s12, 0x000f000f
    s_mov_b32 s13, 0x000f000f
    s_mov_b64 exec, s[12:13]
    buffer_load_dwordx2 v[48:49], v56, s[60:63], s7 offen
    s_lshl_b32 s4, s6, 3
    s_add_u32 s8, s4, 10240
    s_add_u32 s9, s4, 25600
    s_mov_b32 s5, 0
Lpl_82:
    buffer_load_dwordx2 v[50:51], v57, s[52:55], s8 offen sc1
    buffer_load_dwordx2 v[52:53], v57, s[52:55], s9 offen sc1
    s_add_u32 s5, s5, 1
    s_waitcnt vmcnt(0)
    v_max3_u32 v8, v50, v51, v52
    v_max_u32 v8, v8, v53
    v_cmp_eq_u32 vcc, -1, v8
    s_nop 3
    s_cbranch_vccz Lpld_83
    s_sleep 2
    s_cmp_lt_u32 s5, 1048576
    s_cbranch_scc1 Lpl_82
Lpld_83:
    s_lshr_b32 s4, s6, 6
    s_lshl_b32 s4, s4, 9
    s_and_b32 s8, s6, 63
    s_lshl_b32 s8, s8, 1
    s_add_u32 s8, s8, s4
    s_add_u32 s8, s8, 212992
    s_mov_b32 s5, 0
Lpl_84:
    s_add_u32 s9, s8, 0
    buffer_load_dwordx2 v[16:17], v58, s[52:55], s9 offen sc1
    s_add_u32 s9, s8, 5120
    buffer_load_dwordx2 v[18:19], v58, s[52:55], s9 offen sc1
    s_add_u32 s9, s8, 10240
    buffer_load_dwordx2 v[20:21], v58, s[52:55], s9 offen sc1
    s_add_u32 s9, s8, 15360
    buffer_load_dwordx2 v[22:23], v58, s[52:55], s9 offen sc1
    s_add_u32 s9, s8, 20480
    buffer_load_dwordx2 v[24:25], v58, s[52:55], s9 offen sc1
    s_add_u32 s9, s8, 25600
    buffer_load_dwordx2 v[26:27], v58, s[52:55], s9 offen sc1
    s_add_u32 s9, s8, 30720
    buffer_load_dwordx2 v[28:29], v58, s[52:55], s9 offen sc1
    s_add_u32 s9, s8, 35840
    buffer_load_dwordx2 v[30:31], v58, s[52:55], s9 offen sc1
    s_add_u32 s5, s5, 1
    s_waitcnt vmcnt(0)
    v_max3_u32 v8, v16, v17, v18
    v_max3_u32 v8, v8, v19, v20
    v_max3_u32 v8, v8, v21, v22
    v_max3_u32 v8, v8, v23, v24
    v_max3_u32 v8, v8, v25, v26
    v_max3_u32 v8, v8, v27, v28
    v_max3_u32 v8, v8, v29, v30
    v_max_u32 v8, v8, v31
    v_cmp_eq_u32 vcc, -1, v8
    s_nop 3
    s_cbranch_vccz Lpld_85
    s_sleep 4
    s_cmp_lt_u32 s5, 1048576
    s_cbranch_scc1 Lpl_84
Lpld_85:
    s_mov_b64 exec, 1
    ds_add_u32 v2, v0 offset:2960
    s_mov_b64 exec, -1
    v_lshlrev_b32 v68, 16, v16
    v_and_b32 v69, 0xffff0000, v16
    v_lshlrev_b32 v70, 16, v17
    v_and_b32 v71, 0xffff0000, v17
    v_lshlrev_b32 v32, 16, v18
    v_and_b32 v33, 0xffff0000, v18
    v_lshlrev_b32 v34, 16, v19
    v_and_b32 v35, 0xffff0000, v19
    v_add_f32 v68, v68, v32
    v_add_f32 v69, v69, v33
    v_add_f32 v70, v70, v34
    v_add_f32 v71, v71, v35
    v_lshlrev_b32 v32, 16, v20
    v_and_b32 v33, 0xffff0000, v20
    v_lshlrev_b32 v34, 16, v21
    v_and_b32 v35, 0xffff0000, v21
    v_add_f32 v68, v68, v32
    v_add_f32 v69, v69, v33
    v_add_f32 v70, v70, v34
    v_add_f32 v71, v71, v35
    v_lshlrev_b32 v32, 16, v22
    v_and_b32 v33, 0xffff0000, v22
    v_lshlrev_b32 v34, 16, v23
    v_and_b32 v35, 0xffff0000, v23
    v_add_f32 v68, v68, v32
    v_add_f32 v69, v69, v33
    v_add_f32 v70, v70, v34
    v_add_f32 v71, v71, v35
    v_lshlrev_b32 v32, 16, v24
    v_and_b32 v33, 0xffff0000, v24
    v_lshlrev_b32 v34, 16, v25
    v_and_b32 v35, 0xffff0000, v25
    v_add_f32 v68, v68, v32
    v_add_f32 v69, v69, v33
    v_add_f32 v70, v70, v34
    v_add_f32 v71, v71, v35
    v_lshlrev_b32 v32, 16, v26
    v_and_b32 v33, 0xffff0000, v26
    v_lshlrev_b32 v34, 16, v27
    v_and_b32 v35, 0xffff0000, v27
    v_add_f32 v68, v68, v32
    v_add_f32 v69, v69, v33
    v_add_f32 v70, v70, v34
    v_add_f32 v71, v71, v35
    v_lshlrev_b32 v32, 16, v28
    v_and_b32 v33, 0xffff0000, v28
    v_lshlrev_b32 v34, 16, v29
    v_and_b32 v35, 0xffff0000, v29
    v_add_f32 v68, v68, v32
    v_add_f32 v69, v69, v33
    v_add_f32 v70, v70, v34
    v_add_f32 v71, v71, v35
    v_lshlrev_b32 v32, 16, v30
    v_and_b32 v33, 0xffff0000, v30
    v_lshlrev_b32 v34, 16, v31
    v_and_b32 v35, 0xffff0000, v31
    v_add_f32 v68, v68, v32
    v_add_f32 v69, v69, v33
    v_add_f32 v70, v70, v34
    v_add_f32 v71, v71, v35
    v_cvt_pk_bf16_f32 v16, v68, v69
    v_cvt_pk_bf16_f32 v17, v70, v71
    v_lshlrev_b32 v68, 16, v16
    v_and_b32 v69, 0xffff0000, v16
    v_lshlrev_b32 v70, 16, v17
    v_and_b32 v71, 0xffff0000, v17
    v_lshlrev_b32 v20, 16, v50
    v_and_b32 v21, 0xffff0000, v50
    v_lshlrev_b32 v22, 16, v51
    v_and_b32 v23, 0xffff0000, v51
    v_mul_f32 v68, v68, v20
    v_mul_f32 v69, v69, v21
    v_mul_f32 v70, v70, v22
    v_mul_f32 v71, v71, v23
    v_cvt_pk_bf16_f32 v16, v68, v69
    v_cvt_pk_bf16_f32 v17, v70, v71
    v_lshlrev_b32 v68, 16, v16
    v_and_b32 v69, 0xffff0000, v16
    v_lshlrev_b32 v70, 16, v17
    v_and_b32 v71, 0xffff0000, v17
    v_lshlrev_b32 v20, 16, v48
    v_and_b32 v21, 0xffff0000, v48
    v_lshlrev_b32 v22, 16, v49
    v_and_b32 v23, 0xffff0000, v49
    v_add_f32 v68, v68, v20
    v_add_f32 v69, v69, v21
    v_add_f32 v70, v70, v22
    v_add_f32 v71, v71, v23
    v_cvt_pk_bf16_f32 v16, v68, v69
    v_cvt_pk_bf16_f32 v17, v70, v71
    v_lshlrev_b32 v68, 16, v16
    v_and_b32 v69, 0xffff0000, v16
    v_lshlrev_b32 v70, 16, v17
    v_and_b32 v71, 0xffff0000, v17
    v_lshlrev_b32 v60, 16, v52
    v_and_b32 v61, 0xffff0000, v52
    v_lshlrev_b32 v62, 16, v53
    v_and_b32 v63, 0xffff0000, v53
L_D_P6b:
    s_mov_b32 s12, 0x000f000f
    s_mov_b32 s13, 0x000f000f
    s_lshl_b32 s4, s15, 2
    v_add_u32 v9, s4, v2
    s_mov_b32 s5, 0
Lsp_86:
    ds_read_b32 v8, v9 offset:2952
    s_add_u32 s5, s5, 1
    s_waitcnt lgkmcnt(0)
    v_readfirstlane_b32 s4, v8
    s_nop 0
    s_cmp_ge_u32 s4, 4
    s_nop 1
    s_cbranch_scc1 Lspd_87
    s_cmp_lt_u32 s5, 1048576
    s_cbranch_scc1 Lsp_86
Lspd_87:
    ds_read_b128 v[16:19], v4 offset:0
    ds_read_b128 v[20:23], v4 offset:64
    ds_read_b128 v[24:27], v4 offset:128
    ds_read_b128 v[28:31], v4 offset:192
    ds_read_b128 v[32:35], v4 offset:256
    ds_read_b128 v[36:39], v4 offset:320
    ds_read_b128 v[40:43], v4 offset:384
    ds_read_b128 v[44:47], v4 offset:448
    ds_read_b128 v[48:51], v4 offset:512
    ds_read_b128 v[52:55], v4 offset:576
    s_waitcnt lgkmcnt(9)
    v_mfma_f32_16x16x32_bf16 v[64:67], v[72:75], v[16:19], 0
    s_waitcnt lgkmcnt(8)
    v_mfma_f32_16x16x32_bf16 v[64:67], v[76:79], v[20:23], v[64:67]
    ds_read_b128 v[16:19], v4 offset:640
    s_waitcnt lgkmcnt(8)
    v_mfma_f32_16x16x32_bf16 v[64:67], v[80:83], v[24:27], v[64:67]
    ds_read_b128 v[20:23], v4 offset:704
    s_waitcnt lgkmcnt(8)
    v_mfma_f32_16x16x32_bf16 v[64:67], v[84:87], v[28:31], v[64:67]
    ds_read_b128 v[24:27], v4 offset:768
    s_waitcnt lgkmcnt(8)
    v_mfma_f32_16x16x32_bf16 v[64:67], v[88:91], v[32:35], v[64:67]
    ds_read_b128 v[28:31], v4 offset:832
    s_waitcnt lgkmcnt(8)
    v_mfma_f32_16x16x32_bf16 v[64:67], v[92:95], v[36:39], v[64:67]
    ds_read_b128 v[32:35], v4 offset:896
    s_waitcnt lgkmcnt(8)
    v_mfma_f32_16x16x32_bf16 v[64:67], v[96:99], v[40:43], v[64:67]
    ds_read_b128 v[36:39], v4 offset:960
    s_waitcnt lgkmcnt(8)
    v_mfma_f32_16x16x32_bf16 v[64:67], v[100:103], v[44:47], v[64:67]
    ds_read_b128 v[40:43], v4 offset:1024
    s_waitcnt lgkmcnt(8)
    v_mfma_f32_16x16x32_bf16 v[64:67], v[104:107], v[48:51], v[64:67]
    ds_read_b128 v[44:47], v4 offset:1088
    s_waitcnt lgkmcnt(8)
    v_mfma_f32_16x16x32_bf16 v[64:67], v[108:111], v[52:55], v[64:67]
    ds_read_b128 v[48:51], v4 offset:1152
    s_waitcnt lgkmcnt(8)
    v_mfma_f32_16x16x32_bf16 v[64:67], v[112:115], v[16:19], v[64:67]
    ds_read_b128 v[52:55], v4 offset:1216
    s_waitcnt lgkmcnt(8)
    v_mfma_f32_16x16x32_bf16 v[64:67], v[116:119], v[20:23], v[64:67]
    ds_read_b128 v[16:19], v4 offset:1280
    s_waitcnt lgkmcnt(8)
    v_mfma_f32_16x16x32_bf16 v[64:67], v[120:123], v[24:27], v[64:67]
    ds_read_b128 v[20:23], v4 offset:1344
    s_waitcnt lgkmcnt(8)
    v_mfma_f32_16x16x32_bf16 v[64:67], v[124:127], v[28:31], v[64:67]
    ds_read_b128 v[24:27], v4 offset:1408
    s_waitcnt lgkmcnt(8)
    v_mfma_f32_16x16x32_bf16 v[64:67], v[128:131], v[32:35], v[64:67]
    ds_read_b128 v[28:31], v4 offset:1472
    s_waitcnt lgkmcnt(8)
    v_mfma_f32_16x16x32_bf16 v[64:67], v[132:135], v[36:39], v[64:67]
    s_waitcnt lgkmcnt(7)
    v_mfma_f32_16x16x32_bf16 v[64:67], v[136:139], v[40:43], v[64:67]
    s_waitcnt lgkmcnt(6)
    v_mfma_f32_16x16x32_bf16 v[64:67], v[140:143], v[44:47], v[64:67]
    s_waitcnt lgkmcnt(5)
    v_mfma_f32_16x16x32_bf16 v[64:67], v[144:147], v[48:51], v[64:67]
    s_waitcnt lgkmcnt(4)
    v_mfma_f32_16x16x32_bf16 v[64:67], v[148:151], v[52:55], v[64:67]
    s_waitcnt lgkmcnt(3)
    v_mfma_f32_16x16x32_bf16 v[64:67], v[152:155], v[16:19], v[64:67]
    s_waitcnt lgkmcnt(2)
    v_mfma_f32_16x16x32_bf16 v[64:67], v[156:159], v[20:23], v[64:67]
    s_waitcnt lgkmcnt(1)
    v_mfma_f32_16x16x32_bf16 v[64:67], v[160:163], v[24:27], v[64:67]
    s_waitcnt lgkmcnt(0)
    v_mfma_f32_16x16x32_bf16 v[64:67], v[164:167], v[28:31], v[64:67]
    s_cmp_eq_u32 s15, 0
    s_nop 5
    s_cbranch_scc1 L_D_P6c
    s_mov_b64 exec, s[12:13]
    ds_write_b128 v5, v[64:67] offset:1792
    s_mov_b64 exec, 1
    s_lshl_b32 s4, s14, 2
    v_add_u32 v8, s4, v2
    ds_add_u32 v8, v0 offset:2924
    s_waitcnt lgkmcnt(0)
    s_branch L_D_end
L_D_P6c:
    s_lshl_b32 s4, s14, 2
    v_add_u32 v9, s4, v2
    s_mov_b32 s5, 0
Lsp_88:
    ds_read_b32 v8, v9 offset:2924
    s_add_u32 s5, s5, 1
    s_waitcnt lgkmcnt(0)
    v_readfirstlane_b32 s4, v8
    s_nop 0
    s_cmp_ge_u32 s4, 1
    s_nop 1
    s_cbranch_scc1 Lspd_89
    s_cmp_lt_u32 s5, 1048576
    s_cbranch_scc1 Lsp_88
Lspd_89:
    ds_read_b128 v[16:19], v5 offset:1792
    s_waitcnt lgkmcnt(0)
    v_add_f32 v64, v64, v16
    v_add_f32 v65, v65, v17
    v_add_f32 v66, v66, v18
    v_add_f32 v67, v67, v19
    v_cvt_pk_bf16_f32 v16, v64, v65
    v_cvt_pk_bf16_f32 v17, v66, v67
    v_lshlrev_b32 v64, 16, v16
    v_and_b32 v65, 0xffff0000, v16
    v_lshlrev_b32 v66, 16, v17
    v_and_b32 v67, 0xffff0000, v17
    v_mul_f32 v64, v64, v60
    v_mul_f32 v65, v65, v61
    v_mul_f32 v66, v66, v62
    v_mul_f32 v67, v67, v63
    v_cvt_pk_bf16_f32 v16, v64, v65
    v_cvt_pk_bf16_f32 v17, v66, v67
    v_lshlrev_b32 v64, 16, v16
    v_and_b32 v65, 0xffff0000, v16
    v_lshlrev_b32 v66, 16, v17
    v_and_b32 v67, 0xffff0000, v17
    v_add_f32 v64, v64, v68
    v_add_f32 v65, v65, v69
    v_add_f32 v66, v66, v70
    v_add_f32 v67, v67, v71
    v_cvt_pk_bf16_f32 v16, v64, v65
    v_cvt_pk_bf16_f32 v17, v66, v67
    s_mov_b64 exec, s[12:13]
    buffer_store_dwordx2 v[16:17], v6, s[76:79], s7 offen
    s_mov_b64 exec, -1
    s_branch L_D_end
L_D_end:
    s_endpgm
L_end:
    s_endpgm
.fill ((1024 - ((. - adaLN_cond__sliding_block_cached__glu_gated_reglu__decode_kernel) % 1024)) % 1024) / 4, 4, 0xBF800000
L_code_end:
.section .rodata,"a"
.p2align 6
.amdhsa_kernel adaLN_cond__sliding_block_cached__glu_gated_reglu__decode_kernel
  .amdhsa_next_free_vgpr 168
  .amdhsa_next_free_sgpr 102
  .amdhsa_accum_offset 168
  .amdhsa_group_segment_fixed_size 0
  .amdhsa_kernarg_size 112
  .amdhsa_user_sgpr_count 2
  .amdhsa_user_sgpr_kernarg_segment_ptr 1
  .amdhsa_system_sgpr_workgroup_id_x 1
  .amdhsa_float_denorm_mode_32 3
.end_amdhsa_kernel
```
